```python
import torch

def _softmax(x, axis=-1):
    return torch.softmax(x, dim=axis)
def _gelu(x):
    return torch.nn.functional.gelu(x, approximate="tanh")
def _silu(x):
    return torch.nn.functional.silu(x)
def _sigmoid(x):
    return torch.sigmoid(x)
def _layernorm(x, axis=-1, eps=1e-5):
    m = x.mean(dim=axis, keepdim=True)
    v = x.var(dim=axis, keepdim=True, unbiased=False)
    return (x - m) / torch.sqrt(v + eps)
def _scatter_add(tgt, idx, src, axis=0):
    return tgt.clone().index_add_(axis, idx, src)
def _segment_sum(src, seg, n):
    out = torch.zeros((n,) + src.shape[1:], dtype=src.dtype)
    return out.index_add_(0, seg, src)
def _pad(x, pw):
    flat = tuple(v for pair in reversed(pw) for v in pair)
    return torch.nn.functional.pad(x, flat)

kernel_name = 'standalone__weight_only_int_quip__prompt'

def setup_inputs():

    _w = (lambda a: (lambda t: t.to(torch.bfloat16) if t.is_floating_point() else t)(torch.as_tensor(a)))
    B, S, D, F = 1, 2048, 640, 1728
    G = 128 if 128 > 0 else D
    D = (D // G) * G
    ng = D // G
    bits = 4 if 4 > 0 else 4
    qmax = 1 << bits
    qw = torch.randint(0, qmax, (D, F)).to(torch.int32)
    U, _ = (lambda *_a, **_k: torch.linalg.qr(*[torch.as_tensor(_x).float() for _x in _a], **_k))((lambda *s: torch.randn(*s, dtype=torch.bfloat16) * 0.05)(D, D))
    V, _ = (lambda *_a, **_k: torch.linalg.qr(*[torch.as_tensor(_x).float() for _x in _a], **_k))((lambda *s: torch.randn(*s, dtype=torch.bfloat16) * 0.05)(F, F))
    return {
        "x": _w((lambda *s: torch.randn(*s, dtype=torch.bfloat16) * 0.05)(B, S, D)),
        "qw": _w(qw),
        "scales": _w(torch.abs((lambda *s: torch.randn(*s, dtype=torch.bfloat16) * 0.05)(ng, F)) * 0.02 + 0.005),
        "zeros": _w(torch.full((ng, F), qmax / 2.0, dtype=float)),
        "U": _w(U.to(float)),
        "V": _w(V.to(float)),
    }

def reference(x, qw, scales, zeros, U, V):
    B, S, D = x.shape
    ng, F = scales.shape
    G = D // ng
    s = (lambda x, n, axis: torch.repeat_interleave(x, n, dim=axis))(scales, G, axis=0)
    z = (lambda x, n, axis: torch.repeat_interleave(x, n, dim=axis))(zeros, G, axis=0)
    wq = ((lambda x, dt: x.to(dt))(qw, x.dtype) - z) * s
    xr = torch.einsum("bsd,de->bse", x, U)
    h  = torch.einsum("bse,ef->bsf", xr, wq)
    y  = torch.einsum("bsf,fg->bsg", h, V)
    return y
```

```asm
; @launch grid=(256,1,1) block=(512,1,1) lds=163840
.amdgcn_target "amdgcn-amd-amdhsa--gfx950"
.text
.globl standalone__weight_only_int_quip__prompt_kernel
.p2align 8
.type standalone__weight_only_int_quip__prompt_kernel,@function
standalone__weight_only_int_quip__prompt_kernel:
    s_cmp_ge_u32 s2, 256
    s_cbranch_scc1 L_end
    s_load_dwordx16 s[8:23], s[0:1], 0
    s_load_dwordx2 s[24:25], s[0:1], 64
    s_getpc_b64 s[40:41]
L_pc0:
    v_subrev_u32 v4, 504, v0
    v_cmp_gt_u32 vcc, 8, v4
    s_and_saveexec_b64 s[44:45], vcc
    s_cbranch_execz L_noipf
    s_and_b32 s41, s41, 0xffff
    s_mov_b32 s42, L_end - L_pc0
    s_mov_b32 s43, 0x00020000
    s_and_b32 s46, s2, 0xf8
    v_add_lshl_u32 v4, s46, v4, 7
    buffer_load_dword v200, v4, s[40:43], 0 offen
L_noipf:
    s_mov_b64 exec, -1
    v_lshrrev_b32 v1, 6, v0
    v_mov_b32 v2, 163776
    v_mov_b32 v3, 0
    v_readfirstlane_b32 s3, v1
    ds_write2_b32 v2, v3, v3 offset0:0 offset1:1
    v_and_b32 v0, 63, v0
    s_bfe_u32 s4, s2, 0x10002
    s_and_b32 s5, s2, 3
    s_lshr_b32 s6, s2, 3
    s_lshl_b32 s7, s5, 3
    s_lshr_b32 s52, 0xc202020, s7
    s_and_b32 s52, s52, 0xff
    s_lshr_b32 s53, 0x60402000, s7
    s_and_b32 s53, s53, 0xff
    s_cmp_ge_u32 s6, s52
    s_cbranch_scc1 L_xr
    s_add_u32 s53, s53, s6
    s_and_b32 s60, s53, 3
    s_lshl_b32 s4, s4, 2
    s_add_u32 s4, s4, s60
    s_lshr_b32 s5, s53, 2
    s_lshr_b32 s53, s4, 1
    s_lshl_b32 s70, s53, 3
    s_add_u32 s71, s70, 6
    s_lshl_b32 s52, s53, 1
    s_add_u32 s52, s52, 32
    s_bitcmp1_b32 s4, 0
    s_cselect_b32 s71, s52, s71
    s_cselect_b32 s52, 3, 0
    s_add_u32 s70, s70, s52
    s_mul_i32 s68, s5, 1
    s_mul_i32 s52, s60, 7
    s_add_u32 s68, s68, s52
    s_mul_hi_u32 s52, s68, 0x97b425f
    s_mul_i32 s52, s52, 27
    s_sub_u32 s68, s68, s52
    s_cmp_ge_u32 s3, 5
    s_cbranch_scc1 L_wv_nodq
    s_add_u32 s52, s70, s3
    s_add_u32 s54, s71, s3
    s_sub_u32 s54, s54, 3
    s_cmp_ge_u32 s3, 3
    s_cselect_b32 s52, s54, s52
    v_lshrrev_b32 v24, 4, v0
    v_and_b32 v25, 15, v0
    v_mul_u32_u24 v26, 6912, v24
    v_lshl_add_u32 v4, v25, 4, v26
    s_mul_i32 s55, s52, 110592
    s_lshl_b32 s54, s68, 8
    s_add_u32 s55, s55, s54
    s_add_u32 s56, s55, 27648
    s_add_u32 s57, s55, 55296
    s_add_u32 s58, s55, 82944
    s_lshr_b32 s52, s52, 3
    s_mul_i32 s52, s52, 3456
    s_lshl_b32 s54, s68, 7
    s_add_u32 s52, s52, s54
    v_lshlrev_b32 v8, 3, v25
    s_waitcnt lgkmcnt(0)
    s_mov_b32 s36, s12
    s_and_b32 s37, s13, 0xffff
    s_mov_b32 s38, 17280
    s_mov_b32 s39, 0x00020000
    buffer_load_dwordx2 v[10:11], v8, s[36:39], s52 offen
    s_mov_b32 s40, s14
    s_and_b32 s41, s15, 0xffff
    s_mov_b32 s42, 17280
    s_mov_b32 s43, 0x00020000
    buffer_load_dwordx2 v[12:13], v8, s[40:43], s52 offen
    s_mov_b32 s28, s10
    s_and_b32 s29, s11, 0xffff
    s_mov_b32 s30, 4423680
    s_mov_b32 s31, 0x00020000
    buffer_load_dwordx4 v[32:35], v4, s[28:31], s55 offen
    buffer_load_dwordx4 v[36:39], v4, s[28:31], s56 offen
    buffer_load_dwordx4 v[40:43], v4, s[28:31], s57 offen
    buffer_load_dwordx4 v[44:47], v4, s[28:31], s58 offen
    s_barrier
    s_mov_b32 s44, s24
    s_and_b32 s45, s25, 0xffff
    s_mov_b32 s46, 16777216
    s_mov_b32 s47, 0x00020000
    v_lshrrev_b32 v27, 1, v25
    v_lshlrev_b32 v26, 8, v27
    v_and_b32 v28, 1, v25
    v_lshl_add_u32 v26, v28, 3, v26
    s_lshl_b32 s52, s3, 11
    s_add_u32 s52, s52, 151552
    v_add_u32 v26, s52, v26
    v_xor_b32 v27, v27, v24
    v_lshl_add_u32 v4, v27, 4, v26
    v_xor_b32 v5, 64, v4
    v_xor_b32 v28, v0, v24
    v_lshl_add_u32 v28, v28, 4, s52
    v_xor_b32 v29, 64, v28
    s_mul_i32 s52, s4, 27
    s_add_u32 s52, s52, s68
    s_mul_i32 s52, s52, 10240
    s_lshl_b32 s54, s3, 10
    s_add_u32 s52, s52, s54
    s_add_u32 s55, s52, 131072
    s_add_u32 s54, s55, 5120
    v_lshlrev_b32 v9, 4, v0
    s_waitcnt vmcnt(4)
    v_lshlrev_b32 v14, 16, v10
    v_and_b32 v15, 0xffff0000, v10
    v_lshlrev_b32 v18, 16, v12
    v_and_b32 v19, 0xffff0000, v12
    v_lshlrev_b32 v16, 16, v11
    v_and_b32 v17, 0xffff0000, v11
    v_lshlrev_b32 v20, 16, v13
    v_and_b32 v21, 0xffff0000, v13
    v_mul_f32 v18, -v18, v14
    v_mul_f32 v19, -v19, v15
    v_mul_f32 v20, -v20, v16
    v_mul_f32 v21, -v21, v17
    s_waitcnt vmcnt(3)
    v_cvt_f32_i32 v32, v32
    v_cvt_f32_i32 v33, v33
    v_cvt_f32_i32 v34, v34
    v_cvt_f32_i32 v35, v35
    v_fma_f32 v32, v32, v14, v18
    v_fma_f32 v33, v33, v15, v19
    v_fma_f32 v34, v34, v16, v20
    v_fma_f32 v35, v35, v17, v21
    v_cvt_pk_bf16_f32 v32, v32, v33
    v_cvt_pk_bf16_f32 v33, v34, v35
    ds_write_b64 v4, v[32:33] offset:0
    s_waitcnt vmcnt(2)
    v_cvt_f32_i32 v36, v36
    v_cvt_f32_i32 v37, v37
    v_cvt_f32_i32 v38, v38
    v_cvt_f32_i32 v39, v39
    v_fma_f32 v36, v36, v14, v18
    v_fma_f32 v37, v37, v15, v19
    v_fma_f32 v38, v38, v16, v20
    v_fma_f32 v39, v39, v17, v21
    v_cvt_pk_bf16_f32 v36, v36, v37
    v_cvt_pk_bf16_f32 v37, v38, v39
    ds_write_b64 v5, v[36:37] offset:0
    s_waitcnt vmcnt(1)
    v_cvt_f32_i32 v40, v40
    v_cvt_f32_i32 v41, v41
    v_cvt_f32_i32 v42, v42
    v_cvt_f32_i32 v43, v43
    v_fma_f32 v40, v40, v14, v18
    v_fma_f32 v41, v41, v15, v19
    v_fma_f32 v42, v42, v16, v20
    v_fma_f32 v43, v43, v17, v21
    v_cvt_pk_bf16_f32 v40, v40, v41
    v_cvt_pk_bf16_f32 v41, v42, v43
    ds_write_b64 v4, v[40:41] offset:128
    s_waitcnt vmcnt(0)
    v_cvt_f32_i32 v44, v44
    v_cvt_f32_i32 v45, v45
    v_cvt_f32_i32 v46, v46
    v_cvt_f32_i32 v47, v47
    v_fma_f32 v44, v44, v14, v18
    v_fma_f32 v45, v45, v15, v19
    v_fma_f32 v46, v46, v16, v20
    v_fma_f32 v47, v47, v17, v21
    v_cvt_pk_bf16_f32 v44, v44, v45
    v_cvt_pk_bf16_f32 v45, v46, v47
    ds_write_b64 v5, v[44:45] offset:128
    ds_read_b128 v[48:51], v28
    ds_read_b128 v[52:55], v29 offset:1024
    s_waitcnt lgkmcnt(1)
    buffer_store_dwordx4 v[48:51], v9, s[44:47], s55 offen sc1
    s_waitcnt lgkmcnt(0)
    buffer_store_dwordx4 v[52:55], v9, s[44:47], s54 offen sc1
    s_waitcnt vmcnt(0)
    v_mov_b32 v7, 1
    s_mov_b64 exec, 1
    ds_add_u32 v2, v7
    s_mov_b64 exec, -1
    s_cmp_lt_u32 s3, 4
    s_cbranch_scc1 L_wv_cons
    s_branch L_wv_ld
L_wv_nodq:
    s_waitcnt lgkmcnt(0)
    s_barrier
    s_mov_b32 s44, s24
    s_and_b32 s45, s25, 0xffff
    s_mov_b32 s46, 16777216
    s_mov_b32 s47, 0x00020000
L_wv_ld:
    s_and_b32 s62, s3, 1
    s_bfe_u32 s61, s3, 0x10001
    v_lshrrev_b32 v24, 3, v0
    v_and_b32 v25, 7, v0
    v_mul_u32_u24 v26, 3456, v24
    v_bfe_u32 v27, v0, 4, 1
    v_lshlrev_b32 v27, 1, v27
    v_xor_b32 v27, v25, v27
    v_lshl_add_u32 v26, v27, 4, v26
    s_mul_i32 s52, s62, 110592
    s_lshl_b32 s54, s5, 7
    s_add_u32 s52, s52, s54
    v_add_u32 v12, s52, v26
    v_xor_b32 v13, 64, v12
    v_add_u32 v13, 27648, v13
    v_add_u32 v14, 55296, v12
    v_add_u32 v15, 55296, v13
    s_lshl_b32 s66, s62, 12
    s_add_u32 s66, s66, 61440
    s_mov_b32 s32, s18
    s_and_b32 s33, s19, 0xffff
    s_mov_b32 s34, 5971968
    s_mov_b32 s35, 0x00020000
    s_cmp_eq_u32 s61, 0
    s_cbranch_scc1 L_wv_nopre
    s_mov_b32 s57, s68
    s_mov_b32 s56, s66
    s_mov_b32 s65, 0
L_wv_pre:
    s_mov_b32 m0, s56
    s_mul_i32 s58, s57, 221184
    buffer_load_dwordx4 v12, s[32:35], s58 offen lds
    s_add_u32 m0, m0, 1024
    s_nop 0
    buffer_load_dwordx4 v13, s[32:35], s58 offen lds
    s_add_u32 m0, m0, 1024
    s_nop 0
    buffer_load_dwordx4 v14, s[32:35], s58 offen lds
    s_add_u32 m0, m0, 1024
    s_nop 0
    buffer_load_dwordx4 v15, s[32:35], s58 offen lds
    s_add_u32 s57, s57, 1
    s_cmp_eq_u32 s57, 27
    s_cselect_b32 s57, 0, s57
    s_add_u32 s56, s56, 8192
    s_add_u32 s65, s65, 1
    s_cmp_ge_u32 s65, 6
    s_cbranch_scc1 L_wv_pre2
    s_waitcnt vmcnt(6)
    s_cmp_gt_u32 s65, 1
    s_cbranch_scc1 L_wv_pre2
    s_waitcnt vmcnt(0)
L_wv_pre2:
    s_cmp_lt_u32 s65, 9
    s_cbranch_scc1 L_wv_pre
    s_cmp_lt_u32 s7, 24
    s_cbranch_scc1 L_wv_nopre
    s_mov_b32 s36, s8
    s_and_b32 s37, s9, 0xffff
    s_mov_b32 s38, 2621440
    s_mov_b32 s39, 0x00020000
    s_mov_b32 s40, s16
    s_and_b32 s41, s17, 0xffff
    s_mov_b32 s42, 819200
    s_mov_b32 s43, 0x00020000
    s_lshr_b32 s52, s7, 3
    s_sub_u32 s52, s52, 3
    s_mul_i32 s52, s52, 1310720
    s_lshr_b32 s53, s4, 2
    s_mul_i32 s53, s53, 1310720
    s_add_u32 s72, s52, s53
    v_mul_u32_u24 v20, 1280, v0
    v_lshlrev_b32 v21, 7, v0
    s_lshl_b32 s73, s6, 1
    s_add_u32 s73, s73, s62
L_wv_pf:
    s_mul_hi_u32 s52, s73, 0x9d89d8a
    s_mul_i32 s53, s52, 26
    s_sub_u32 s53, s73, s53
    s_add_u32 s52, s52, 8
    s_cmp_ge_u32 s53, 16
    s_cbranch_scc1 L_wv_pfu
    s_mul_i32 s53, s53, 81920
    s_lshl_b32 s52, s52, 7
    s_add_u32 s52, s52, s53
    s_add_u32 s52, s52, s72
    buffer_load_dword v201, v20, s[36:39], s52 offen
    s_branch L_wv_pfn
L_wv_pfu:
    s_mul_i32 s52, s52, 10
    s_add_u32 s52, s52, s53
    s_sub_u32 s52, s52, 16
    s_lshl_b32 s52, s52, 13
    buffer_load_dword v201, v21, s[40:43], s52 offen
L_wv_pfn:
    s_add_u32 s73, s73, 24
    s_cmp_lt_u32 s73, 52
    s_waitcnt vmcnt(8)
    s_cbranch_scc1 L_wv_pf
L_wv_nopre:
    s_mul_i32 s52, s4, 6912
    s_add_u32 s52, s52, 0
    v_lshl_add_u32 v6, v0, 8, s52
    s_lshl_b32 s53, s5, 8
    s_add_u32 s52, s52, s53
    v_lshl_add_u32 v8, v0, 2, s52
    s_lshl_b32 s52, s5, 2
    s_mul_hi_u32 s72, s52, 0x24924925
    s_add_u32 s52, s52, 3
    s_mul_hi_u32 s73, s52, 0x24924925
    s_cmp_eq_u32 s72, s73
    s_cselect_b32 s74, 0xffff, -1
    v_bfe_u32 v18, v0, 4, 1
    v_add_u32 v18, s72, v18
    v_and_b32 v16, 15, v0
    v_lshl_add_u32 v16, v16, 4, v18
    v_lshlrev_b32 v16, 8, v16
    v_add_u32 v16, 65536, v16
    v_mul_u32_u24 v18, 7, v18
    v_lshrrev_b32 v18, 2, v18
    v_sub_u32 v18, s5, v18
    v_lshl_add_u32 v17, v18, 5, v16
    s_lshl_b32 s75, s4, 2
    s_cmp_lg_u32 s3, 5
    s_cbranch_scc1 L_wv_go
    s_lshl_b32 s53, s68, 2
    s_mov_b64 exec, 0x7ffffff
    buffer_load_dword v11, v6, s[44:47], 0 offen offset:124 sc1
    s_mov_b32 exec_lo, s74
    buffer_load_dword v19, v16, s[44:47], 0 offen offset:124 sc1
    s_mov_b32 exec_lo, 0x7ffffff
    s_waitcnt vmcnt(1)
    v_add_u32 v11, 1540483477, v11
    s_mov_b32 s80, 0
L_wv_own:
    ds_read_b32 v30, v2
    s_add_u32 s80, s80, 1
    s_cmp_ge_u32 s80, 524288
    s_cbranch_scc1 L_wv_own_done
    s_waitcnt lgkmcnt(0)
    v_readfirstlane_b32 s52, v30
    s_cmp_ge_u32 s52, 5
    s_cbranch_scc0 L_wv_own
L_wv_own_done:
    buffer_atomic_swap v11, v6, s[44:47], s53 offen sc1
    s_mov_b64 exec, -1
L_wv_go:
    s_mul_i32 s52, s4, 276480
    s_mul_i32 s55, s62, 5120
    s_add_u32 s52, s52, s55
    s_add_u32 s52, s52, 131072
    v_lshl_add_u32 v9, v0, 4, s52
    v_add_u32 v10, 4096, v9
    s_mul_i32 s52, s61, 10240
    s_add_u32 s55, s55, s52
    s_add_u32 s57, s68, s61
    s_add_u32 s57, s57, 1
    s_sub_u32 s52, s57, 27
    s_cselect_b32 s57, s57, s52
    s_add_u32 s67, s57, 8
    s_sub_u32 s52, s67, 27
    s_cselect_b32 s67, s67, s52
    s_lshl_b32 s69, s61, 13
    s_add_u32 s69, s69, 73728
    s_cmp_lg_u32 s3, 4
    s_cbranch_scc1 L_wv_np
    s_mov_b32 s76, 67108863
    s_mov_b32 s77, 0
    s_lshl_b64 s[76:77], s[76:77], s57
    s_lshr_b64 s[78:79], s[76:77], 27
    s_or_b32 s76, s76, s78
    s_and_b32 s76, s76, 0x7ffffff
    s_call_b64 s[78:79], L_poll
    v_mov_b32 v30, s63
    ds_write_b32 v2, v30 offset:4
    s_branch L_wv_np2
L_wv_np:
    s_mov_b32 s80, 0
L_wv_lm:
    s_sleep 1
    ds_read_b32 v30, v2 offset:4
    s_add_u32 s80, s80, 1
    s_cmp_ge_u32 s80, 524288
    s_cbranch_scc1 L_wv_lm_done
    s_waitcnt lgkmcnt(0)
    v_readfirstlane_b32 s63, v30
    s_cmp_lg_u32 s63, 0
    s_cbranch_scc0 L_wv_lm
L_wv_lm_done:
L_wv_np2:
    s_mul_i32 s64, s57, 10240
    s_add_u32 s57, s57, 2
    s_sub_u32 s52, s57, 27
    s_cselect_b32 s57, s57, s52
    s_add_u32 m0, s55, 0
    s_nop 0
    buffer_load_dwordx4 v9, s[44:47], s64 offen offset:0 sc1 lds
    buffer_load_dwordx4 v9, s[44:47], s64 offen offset:1024 sc1 lds
    buffer_load_dwordx4 v9, s[44:47], s64 offen offset:2048 sc1 lds
    buffer_load_dwordx4 v9, s[44:47], s64 offen offset:3072 sc1 lds
    s_add_u32 m0, m0, 4096
    s_nop 0
    buffer_load_dwordx4 v10, s[44:47], s64 offen sc1 lds
    s_mul_i32 s64, s57, 10240
    s_add_u32 s57, s57, 2
    s_sub_u32 s52, s57, 27
    s_cselect_b32 s57, s57, s52
    s_add_u32 m0, s55, 20480
    s_nop 0
    buffer_load_dwordx4 v9, s[44:47], s64 offen offset:0 sc1 lds
    buffer_load_dwordx4 v9, s[44:47], s64 offen offset:1024 sc1 lds
    buffer_load_dwordx4 v9, s[44:47], s64 offen offset:2048 sc1 lds
    buffer_load_dwordx4 v9, s[44:47], s64 offen offset:3072 sc1 lds
    s_add_u32 m0, m0, 4096
    s_nop 0
    buffer_load_dwordx4 v10, s[44:47], s64 offen sc1 lds
    s_mul_i32 s58, s67, 221184
    s_add_u32 s67, s67, 2
    s_sub_u32 s52, s67, 27
    s_cselect_b32 s67, s67, s52
    s_add_u32 s56, s66, s69
    s_add_u32 s69, s69, 16384
    s_sub_u32 s52, s69, 90112
    s_cselect_b32 s69, s69, s52
    s_mul_i32 s64, s57, 10240
    s_add_u32 s57, s57, 2
    s_sub_u32 s52, s57, 27
    s_cselect_b32 s57, s57, s52
    s_add_u32 m0, s55, 40960
    s_waitcnt vmcnt(5)
    s_barrier
    buffer_load_dwordx4 v9, s[44:47], s64 offen offset:0 sc1 lds
    buffer_load_dwordx4 v9, s[44:47], s64 offen offset:1024 sc1 lds
    buffer_load_dwordx4 v9, s[44:47], s64 offen offset:2048 sc1 lds
    buffer_load_dwordx4 v9, s[44:47], s64 offen offset:3072 sc1 lds
    s_add_u32 m0, m0, 4096
    s_nop 0
    buffer_load_dwordx4 v10, s[44:47], s64 offen sc1 lds
    s_mov_b32 m0, s56
    s_nop 0
    buffer_load_dwordx4 v12, s[32:35], s58 offen lds
    s_add_u32 m0, m0, 1024
    s_nop 0
    buffer_load_dwordx4 v13, s[32:35], s58 offen lds
    s_add_u32 m0, m0, 1024
    s_nop 0
    buffer_load_dwordx4 v14, s[32:35], s58 offen lds
    s_add_u32 m0, m0, 1024
    s_nop 0
    buffer_load_dwordx4 v15, s[32:35], s58 offen lds
    s_mul_i32 s58, s67, 221184
    s_add_u32 s67, s67, 2
    s_sub_u32 s52, s67, 27
    s_cselect_b32 s67, s67, s52
    s_add_u32 s56, s66, s69
    s_add_u32 s69, s69, 16384
    s_sub_u32 s52, s69, 90112
    s_cselect_b32 s69, s69, s52
    s_mul_i32 s64, s57, 10240
    s_add_u32 s57, s57, 2
    s_sub_u32 s52, s57, 27
    s_cselect_b32 s57, s57, s52
    s_add_u32 m0, s55, 0
    s_waitcnt vmcnt(9)
    s_barrier
    buffer_load_dwordx4 v9, s[44:47], s64 offen offset:0 sc1 lds
    buffer_load_dwordx4 v9, s[44:47], s64 offen offset:1024 sc1 lds
    buffer_load_dwordx4 v9, s[44:47], s64 offen offset:2048 sc1 lds
    buffer_load_dwordx4 v9, s[44:47], s64 offen offset:3072 sc1 lds
    s_add_u32 m0, m0, 4096
    s_nop 0
    buffer_load_dwordx4 v10, s[44:47], s64 offen sc1 lds
    s_mov_b32 m0, s56
    s_nop 0
    buffer_load_dwordx4 v12, s[32:35], s58 offen lds
    s_add_u32 m0, m0, 1024
    s_nop 0
    buffer_load_dwordx4 v13, s[32:35], s58 offen lds
    s_add_u32 m0, m0, 1024
    s_nop 0
    buffer_load_dwordx4 v14, s[32:35], s58 offen lds
    s_add_u32 m0, m0, 1024
    s_nop 0
    buffer_load_dwordx4 v15, s[32:35], s58 offen lds
    s_mul_i32 s58, s67, 221184
    s_add_u32 s67, s67, 2
    s_sub_u32 s52, s67, 27
    s_cselect_b32 s67, s67, s52
    s_add_u32 s56, s66, s69
    s_add_u32 s69, s69, 16384
    s_sub_u32 s52, s69, 90112
    s_cselect_b32 s69, s69, s52
    s_mul_i32 s64, s57, 10240
    s_add_u32 s57, s57, 2
    s_sub_u32 s52, s57, 27
    s_cselect_b32 s57, s57, s52
    s_add_u32 m0, s55, 20480
    s_waitcnt vmcnt(13)
    s_barrier
    buffer_load_dwordx4 v9, s[44:47], s64 offen offset:0 sc1 lds
    buffer_load_dwordx4 v9, s[44:47], s64 offen offset:1024 sc1 lds
    buffer_load_dwordx4 v9, s[44:47], s64 offen offset:2048 sc1 lds
    buffer_load_dwordx4 v9, s[44:47], s64 offen offset:3072 sc1 lds
    s_add_u32 m0, m0, 4096
    s_nop 0
    buffer_load_dwordx4 v10, s[44:47], s64 offen sc1 lds
    s_mov_b32 m0, s56
    s_nop 0
    buffer_load_dwordx4 v12, s[32:35], s58 offen lds
    s_add_u32 m0, m0, 1024
    s_nop 0
    buffer_load_dwordx4 v13, s[32:35], s58 offen lds
    s_add_u32 m0, m0, 1024
    s_nop 0
    buffer_load_dwordx4 v14, s[32:35], s58 offen lds
    s_add_u32 m0, m0, 1024
    s_nop 0
    buffer_load_dwordx4 v15, s[32:35], s58 offen lds
    s_mul_i32 s58, s67, 221184
    s_add_u32 s67, s67, 2
    s_sub_u32 s52, s67, 27
    s_cselect_b32 s67, s67, s52
    s_add_u32 s56, s66, s69
    s_add_u32 s69, s69, 16384
    s_sub_u32 s52, s69, 90112
    s_cselect_b32 s69, s69, s52
    s_mul_i32 s64, s57, 10240
    s_add_u32 s57, s57, 2
    s_sub_u32 s52, s57, 27
    s_cselect_b32 s57, s57, s52
    s_add_u32 m0, s55, 40960
    s_waitcnt vmcnt(13)
    s_barrier
    buffer_load_dwordx4 v9, s[44:47], s64 offen offset:0 sc1 lds
    buffer_load_dwordx4 v9, s[44:47], s64 offen offset:1024 sc1 lds
    buffer_load_dwordx4 v9, s[44:47], s64 offen offset:2048 sc1 lds
    buffer_load_dwordx4 v9, s[44:47], s64 offen offset:3072 sc1 lds
    s_add_u32 m0, m0, 4096
    s_nop 0
    buffer_load_dwordx4 v10, s[44:47], s64 offen sc1 lds
    s_mov_b32 m0, s56
    s_nop 0
    buffer_load_dwordx4 v12, s[32:35], s58 offen lds
    s_add_u32 m0, m0, 1024
    s_nop 0
    buffer_load_dwordx4 v13, s[32:35], s58 offen lds
    s_add_u32 m0, m0, 1024
    s_nop 0
    buffer_load_dwordx4 v14, s[32:35], s58 offen lds
    s_add_u32 m0, m0, 1024
    s_nop 0
    buffer_load_dwordx4 v15, s[32:35], s58 offen lds
    s_mul_i32 s58, s67, 221184
    s_add_u32 s67, s67, 2
    s_sub_u32 s52, s67, 27
    s_cselect_b32 s67, s67, s52
    s_add_u32 s56, s66, s69
    s_add_u32 s69, s69, 16384
    s_sub_u32 s52, s69, 90112
    s_cselect_b32 s69, s69, s52
    s_mul_i32 s64, s57, 10240
    s_add_u32 s57, s57, 2
    s_sub_u32 s52, s57, 27
    s_cselect_b32 s57, s57, s52
    s_add_u32 m0, s55, 0
    s_waitcnt vmcnt(13)
    s_barrier
    buffer_load_dwordx4 v9, s[44:47], s64 offen offset:0 sc1 lds
    buffer_load_dwordx4 v9, s[44:47], s64 offen offset:1024 sc1 lds
    buffer_load_dwordx4 v9, s[44:47], s64 offen offset:2048 sc1 lds
    buffer_load_dwordx4 v9, s[44:47], s64 offen offset:3072 sc1 lds
    s_add_u32 m0, m0, 4096
    s_nop 0
    buffer_load_dwordx4 v10, s[44:47], s64 offen sc1 lds
    s_mov_b32 m0, s56
    s_nop 0
    buffer_load_dwordx4 v12, s[32:35], s58 offen lds
    s_add_u32 m0, m0, 1024
    s_nop 0
    buffer_load_dwordx4 v13, s[32:35], s58 offen lds
    s_add_u32 m0, m0, 1024
    s_nop 0
    buffer_load_dwordx4 v14, s[32:35], s58 offen lds
    s_add_u32 m0, m0, 1024
    s_nop 0
    buffer_load_dwordx4 v15, s[32:35], s58 offen lds
    s_mul_i32 s58, s67, 221184
    s_add_u32 s67, s67, 2
    s_sub_u32 s52, s67, 27
    s_cselect_b32 s67, s67, s52
    s_add_u32 s56, s66, s69
    s_add_u32 s69, s69, 16384
    s_sub_u32 s52, s69, 90112
    s_cselect_b32 s69, s69, s52
    s_mul_i32 s64, s57, 10240
    s_add_u32 s57, s57, 2
    s_sub_u32 s52, s57, 27
    s_cselect_b32 s57, s57, s52
    s_add_u32 m0, s55, 20480
    s_waitcnt vmcnt(13)
    s_barrier
    buffer_load_dwordx4 v9, s[44:47], s64 offen offset:0 sc1 lds
    buffer_load_dwordx4 v9, s[44:47], s64 offen offset:1024 sc1 lds
    buffer_load_dwordx4 v9, s[44:47], s64 offen offset:2048 sc1 lds
    buffer_load_dwordx4 v9, s[44:47], s64 offen offset:3072 sc1 lds
    s_add_u32 m0, m0, 4096
    s_nop 0
    buffer_load_dwordx4 v10, s[44:47], s64 offen sc1 lds
    s_mov_b32 m0, s56
    s_nop 0
    buffer_load_dwordx4 v12, s[32:35], s58 offen lds
    s_add_u32 m0, m0, 1024
    s_nop 0
    buffer_load_dwordx4 v13, s[32:35], s58 offen lds
    s_add_u32 m0, m0, 1024
    s_nop 0
    buffer_load_dwordx4 v14, s[32:35], s58 offen lds
    s_add_u32 m0, m0, 1024
    s_nop 0
    buffer_load_dwordx4 v15, s[32:35], s58 offen lds
    s_mul_i32 s58, s67, 221184
    s_add_u32 s67, s67, 2
    s_sub_u32 s52, s67, 27
    s_cselect_b32 s67, s67, s52
    s_add_u32 s56, s66, s69
    s_add_u32 s69, s69, 16384
    s_sub_u32 s52, s69, 90112
    s_cselect_b32 s69, s69, s52
    s_mul_i32 s64, s57, 10240
    s_add_u32 s57, s57, 2
    s_sub_u32 s52, s57, 27
    s_cselect_b32 s57, s57, s52
    s_add_u32 m0, s55, 40960
    s_waitcnt vmcnt(13)
    s_barrier
    buffer_load_dwordx4 v9, s[44:47], s64 offen offset:0 sc1 lds
    buffer_load_dwordx4 v9, s[44:47], s64 offen offset:1024 sc1 lds
    buffer_load_dwordx4 v9, s[44:47], s64 offen offset:2048 sc1 lds
    buffer_load_dwordx4 v9, s[44:47], s64 offen offset:3072 sc1 lds
    s_add_u32 m0, m0, 4096
    s_nop 0
    buffer_load_dwordx4 v10, s[44:47], s64 offen sc1 lds
    s_mov_b32 m0, s56
    s_nop 0
    buffer_load_dwordx4 v12, s[32:35], s58 offen lds
    s_add_u32 m0, m0, 1024
    s_nop 0
    buffer_load_dwordx4 v13, s[32:35], s58 offen lds
    s_add_u32 m0, m0, 1024
    s_nop 0
    buffer_load_dwordx4 v14, s[32:35], s58 offen lds
    s_add_u32 m0, m0, 1024
    s_nop 0
    buffer_load_dwordx4 v15, s[32:35], s58 offen lds
    s_mul_i32 s58, s67, 221184
    s_add_u32 s67, s67, 2
    s_sub_u32 s52, s67, 27
    s_cselect_b32 s67, s67, s52
    s_add_u32 s56, s66, s69
    s_add_u32 s69, s69, 16384
    s_sub_u32 s52, s69, 90112
    s_cselect_b32 s69, s69, s52
    s_mul_i32 s64, s57, 10240
    s_add_u32 s57, s57, 2
    s_sub_u32 s52, s57, 27
    s_cselect_b32 s57, s57, s52
    s_add_u32 m0, s55, 0
    s_waitcnt vmcnt(13)
    s_barrier
    buffer_load_dwordx4 v9, s[44:47], s64 offen offset:0 sc1 lds
    buffer_load_dwordx4 v9, s[44:47], s64 offen offset:1024 sc1 lds
    buffer_load_dwordx4 v9, s[44:47], s64 offen offset:2048 sc1 lds
    buffer_load_dwordx4 v9, s[44:47], s64 offen offset:3072 sc1 lds
    s_add_u32 m0, m0, 4096
    s_nop 0
    buffer_load_dwordx4 v10, s[44:47], s64 offen sc1 lds
    s_mov_b32 m0, s56
    s_nop 0
    buffer_load_dwordx4 v12, s[32:35], s58 offen lds
    s_add_u32 m0, m0, 1024
    s_nop 0
    buffer_load_dwordx4 v13, s[32:35], s58 offen lds
    s_add_u32 m0, m0, 1024
    s_nop 0
    buffer_load_dwordx4 v14, s[32:35], s58 offen lds
    s_add_u32 m0, m0, 1024
    s_nop 0
    buffer_load_dwordx4 v15, s[32:35], s58 offen lds
    s_mul_i32 s58, s67, 221184
    s_add_u32 s67, s67, 2
    s_sub_u32 s52, s67, 27
    s_cselect_b32 s67, s67, s52
    s_add_u32 s56, s66, s69
    s_add_u32 s69, s69, 16384
    s_sub_u32 s52, s69, 90112
    s_cselect_b32 s69, s69, s52
    s_mul_i32 s64, s57, 10240
    s_add_u32 s57, s57, 2
    s_sub_u32 s52, s57, 27
    s_cselect_b32 s57, s57, s52
    s_add_u32 m0, s55, 20480
    s_waitcnt vmcnt(13)
    s_barrier
    buffer_load_dwordx4 v9, s[44:47], s64 offen offset:0 sc1 lds
    buffer_load_dwordx4 v9, s[44:47], s64 offen offset:1024 sc1 lds
    buffer_load_dwordx4 v9, s[44:47], s64 offen offset:2048 sc1 lds
    buffer_load_dwordx4 v9, s[44:47], s64 offen offset:3072 sc1 lds
    s_add_u32 m0, m0, 4096
    s_nop 0
    buffer_load_dwordx4 v10, s[44:47], s64 offen sc1 lds
    s_mov_b32 m0, s56
    s_nop 0
    buffer_load_dwordx4 v12, s[32:35], s58 offen lds
    s_add_u32 m0, m0, 1024
    s_nop 0
    buffer_load_dwordx4 v13, s[32:35], s58 offen lds
    s_add_u32 m0, m0, 1024
    s_nop 0
    buffer_load_dwordx4 v14, s[32:35], s58 offen lds
    s_add_u32 m0, m0, 1024
    s_nop 0
    buffer_load_dwordx4 v15, s[32:35], s58 offen lds
    s_mul_i32 s64, s57, 10240
    s_add_u32 s57, s57, 2
    s_sub_u32 s52, s57, 27
    s_cselect_b32 s57, s57, s52
    s_add_u32 m0, s55, 40960
    s_waitcnt vmcnt(13)
    s_barrier
    buffer_load_dwordx4 v9, s[44:47], s64 offen offset:0 sc1 lds
    buffer_load_dwordx4 v9, s[44:47], s64 offen offset:1024 sc1 lds
    buffer_load_dwordx4 v9, s[44:47], s64 offen offset:2048 sc1 lds
    buffer_load_dwordx4 v9, s[44:47], s64 offen offset:3072 sc1 lds
    s_add_u32 m0, m0, 4096
    s_nop 0
    buffer_load_dwordx4 v10, s[44:47], s64 offen sc1 lds
    s_mul_i32 s64, s57, 10240
    s_add_u32 s57, s57, 2
    s_sub_u32 s52, s57, 27
    s_cselect_b32 s57, s57, s52
    s_add_u32 m0, s55, 0
    s_waitcnt vmcnt(9)
    s_barrier
    buffer_load_dwordx4 v9, s[44:47], s64 offen offset:0 sc1 lds
    buffer_load_dwordx4 v9, s[44:47], s64 offen offset:1024 sc1 lds
    buffer_load_dwordx4 v9, s[44:47], s64 offen offset:2048 sc1 lds
    buffer_load_dwordx4 v9, s[44:47], s64 offen offset:3072 sc1 lds
    s_add_u32 m0, m0, 4096
    s_nop 0
    buffer_load_dwordx4 v10, s[44:47], s64 offen sc1 lds
    s_waitcnt vmcnt(5)
    s_barrier
    s_waitcnt vmcnt(0)
    s_barrier
    s_cmp_lg_u32 s3, 4
    s_cbranch_scc1 L_wv_nobump
    v_mov_b32 v30, 1
    s_mov_b64 exec, 1
    buffer_atomic_add v30, v8, s[44:47], 0 offen offset:124 sc1
    s_mov_b64 exec, -1
L_wv_nobump:
    s_mov_b32 s53, 9
    s_branch L_c_ld
L_wv_cons:
    s_and_b32 s60, s3, 1
    s_lshr_b32 s61, s3, 1
    s_mul_i32 s52, s61, 5120
    v_lshl_add_u32 v48, v0, 4, s52
    s_lshl_b32 s54, s61, 2
    v_or_b32 v28, s54, v24
    v_xor_b32 v28, v28, v0
    s_lshl_b32 s52, s61, 10
    s_add_u32 s52, s52, 151552
    v_lshl_add_u32 v57, v28, 4, s52
    s_lshl_b32 s63, s60, 1
    s_add_u32 s63, s63, s61
    v_bfe_u32 v28, v0, 2, 2
    v_lshl_add_u32 v28, v24, 3, v28
    v_lshlrev_b32 v28, 7, v28
    v_bfe_u32 v29, v0, 3, 2
    v_xor_b32 v29, s63, v29
    v_lshl_add_u32 v28, v29, 5, v28
    v_and_b32 v29, 3, v0
    v_lshl_add_u32 v28, v29, 3, v28
    s_lshl_b32 s52, s61, 12
    s_add_u32 s52, s52, 61440
    v_add_u32 v49, s52, v28
    v_xor_b32 v50, 32, v49
    s_lshl_b32 s52, s5, 2
    s_add_u32 s52, s52, s63
    s_mul_hi_u32 s54, s52, 0x24924925
    s_mul_i32 s64, s54, 7
    s_sub_u32 s52, s52, s64
    s_mov_b32 s64, s54
    s_mul_i32 s54, s64, 143360
    s_add_u32 s54, s54, 2359296
    v_bfe_u32 v28, v0, 2, 1
    v_lshlrev_b32 v28, 10, v28
    v_bfe_u32 v29, v0, 3, 1
    v_lshl_add_u32 v28, v29, 6, v28
    v_and_b32 v29, 3, v0
    v_lshl_add_u32 v28, v29, 4, v28
    v_lshlrev_b32 v29, 4, v25
    s_cmp_eq_u32 s52, 6
    s_cselect_b64 vcc, -1, 0
    s_and_b32 s64, s52, 6
    s_lshl_b32 s64, s64, 10
    s_and_b32 s52, s52, 1
    s_lshl_b32 s52, s52, 7
    s_add_u32 s54, s54, s64
    s_add_u32 s54, s54, s52
    v_cndmask_b32 v28, v28, v29, vcc
    v_lshrrev_b32 v29, 1, v24
    v_lshl_add_u32 v28, v29, 8, v28
    v_add_u32 v28, s54, v28
    s_add_u32 s52, s70, 0
    s_lshr_b32 s72, s52, 1
    s_mul_i32 s72, s72, 7168
    s_and_b32 s52, s52, 1
    s_lshl_b32 s52, s52, 9
    s_add_u32 s72, s72, s52
    s_add_u32 s52, s70, 1
    s_lshr_b32 s73, s52, 1
    s_mul_i32 s73, s73, 7168
    s_and_b32 s52, s52, 1
    s_lshl_b32 s52, s52, 9
    s_add_u32 s73, s73, s52
    s_add_u32 s52, s70, 2
    s_lshr_b32 s74, s52, 1
    s_mul_i32 s74, s74, 7168
    s_and_b32 s52, s52, 1
    s_lshl_b32 s52, s52, 9
    s_add_u32 s74, s74, s52
    s_add_u32 s52, s71, 0
    s_lshr_b32 s75, s52, 1
    s_mul_i32 s75, s75, 7168
    s_and_b32 s52, s52, 1
    s_lshl_b32 s52, s52, 9
    s_add_u32 s75, s75, s52
    s_add_u32 s52, s71, 1
    s_lshr_b32 s76, s52, 1
    s_mul_i32 s76, s76, 7168
    s_and_b32 s52, s52, 1
    s_lshl_b32 s52, s52, 9
    s_add_u32 s76, s76, s52
    s_mov_b32 s77, 0x40000000
    v_and_b32 v29, 1, v24
    v_cmp_eq_u32 vcc, 1, v29
    v_mov_b32 v29, s72
    v_mov_b32 v30, s73
    v_cndmask_b32 v29, v29, v30, vcc
    v_add_u32 v58, v28, v29
    v_mov_b32 v29, s74
    v_mov_b32 v30, s75
    v_cndmask_b32 v29, v29, v30, vcc
    v_add_u32 v59, v28, v29
    v_mov_b32 v29, s76
    v_mov_b32 v30, s77
    v_cndmask_b32 v29, v29, v30, vcc
    v_add_u32 v60, v28, v29
    v_mov_b32 v120, 0
    v_mov_b32 v121, 0
    v_mov_b32 v122, 0
    v_mov_b32 v123, 0
    v_mov_b32 v124, 0
    v_mov_b32 v125, 0
    v_mov_b32 v126, 0
    v_mov_b32 v127, 0
    v_mov_b32 v128, 0
    v_mov_b32 v129, 0
    v_mov_b32 v130, 0
    v_mov_b32 v131, 0
    v_mov_b32 v132, 0
    v_mov_b32 v133, 0
    v_mov_b32 v134, 0
    v_mov_b32 v135, 0
    v_mov_b32 v136, 0
    v_mov_b32 v137, 0
    v_mov_b32 v138, 0
    v_mov_b32 v139, 0
    v_mov_b32 v140, 0
    v_mov_b32 v141, 0
    v_mov_b32 v142, 0
    v_mov_b32 v143, 0
    v_mov_b32 v144, 0
    v_mov_b32 v145, 0
    v_mov_b32 v146, 0
    v_mov_b32 v147, 0
    v_mov_b32 v148, 0
    v_mov_b32 v149, 0
    v_mov_b32 v150, 0
    v_mov_b32 v151, 0
    v_mov_b32 v152, 0
    v_mov_b32 v153, 0
    v_mov_b32 v154, 0
    v_mov_b32 v155, 0
    v_mov_b32 v156, 0
    v_mov_b32 v157, 0
    v_mov_b32 v158, 0
    v_mov_b32 v159, 0
    s_mul_i32 s52, s3, 5120
    s_add_u32 s52, s52, 126976
    v_lshl_add_u32 v55, v0, 4, s52
    s_xor_b32 s52, s3, 2
    s_mul_i32 s52, s52, 5120
    s_add_u32 s52, s52, 126976
    v_lshl_add_u32 v56, v0, 4, s52
    s_mov_b32 s56, 0
    s_mov_b32 s57, 8192
    v_add_u32 v51, s56, v48
    s_add_u32 s56, s56, 20480
    s_cmp_eq_u32 s56, 61440
    s_cselect_b32 s56, 0, s56
    v_add_u32 v52, s57, v49
    v_add_u32 v53, s57, v50
    s_add_u32 s57, s57, 8192
    s_cmp_eq_u32 s57, 90112
    s_cselect_b32 s57, 0, s57
    s_mov_b32 s65, 0
    s_barrier
    ds_read_b64_tr_b16 v[112:113], v49 offset:0
    ds_read_b64_tr_b16 v[114:115], v49 offset:512
    ds_read_b64_tr_b16 v[116:117], v50 offset:0
    ds_read_b64_tr_b16 v[118:119], v50 offset:512
    ds_read_b128 v[92:95], v57 offset:0
    ds_read_b128 v[96:99], v57 offset:2048
    ds_read_b128 v[100:103], v57 offset:4096
    ds_read_b128 v[104:107], v57 offset:6144
    ds_read_b128 v[108:111], v57 offset:8192
    s_waitcnt lgkmcnt(0)
    s_branch L_wv_cent
L_wv_cloop:
    s_waitcnt lgkmcnt(0)
    s_barrier
L_wv_cent:
    ds_read_b64_tr_b16 v[84:85], v52 offset:0
    ds_read_b64_tr_b16 v[86:87], v52 offset:512
    v_mfma_f32_16x16x32_bf16 v[120:123], v[92:95], v[112:115], v[120:123]
    ds_read_b64_tr_b16 v[88:89], v53 offset:0
    ds_read_b64_tr_b16 v[90:91], v53 offset:512
    v_mfma_f32_16x16x32_bf16 v[140:143], v[92:95], v[116:119], v[140:143]
    ds_read_b128 v[64:67], v51 offset:0
    v_mfma_f32_16x16x32_bf16 v[124:127], v[96:99], v[112:115], v[124:127]
    ds_read_b128 v[68:71], v51 offset:1024
    v_mfma_f32_16x16x32_bf16 v[144:147], v[96:99], v[116:119], v[144:147]
    ds_read_b128 v[72:75], v51 offset:2048
    v_mfma_f32_16x16x32_bf16 v[128:131], v[100:103], v[112:115], v[128:131]
    ds_read_b128 v[76:79], v51 offset:3072
    v_mfma_f32_16x16x32_bf16 v[148:151], v[100:103], v[116:119], v[148:151]
    ds_read_b128 v[80:83], v51 offset:4096
    v_mfma_f32_16x16x32_bf16 v[132:135], v[104:107], v[112:115], v[132:135]
    v_add_u32 v52, s57, v49
    v_add_u32 v53, s57, v50
    s_add_u32 s57, s57, 8192
    v_mfma_f32_16x16x32_bf16 v[152:155], v[104:107], v[116:119], v[152:155]
    s_cmp_eq_u32 s57, 90112
    s_cselect_b32 s57, 0, s57
    v_mfma_f32_16x16x32_bf16 v[136:139], v[108:111], v[112:115], v[136:139]
    v_mfma_f32_16x16x32_bf16 v[156:159], v[108:111], v[116:119], v[156:159]
    ds_read_b64_tr_b16 v[112:113], v52 offset:0
    ds_read_b64_tr_b16 v[114:115], v52 offset:512
    s_waitcnt lgkmcnt(5)
    v_mfma_f32_16x16x32_bf16 v[120:123], v[64:67], v[84:87], v[120:123]
    ds_read_b64_tr_b16 v[116:117], v53 offset:0
    ds_read_b64_tr_b16 v[118:119], v53 offset:512
    v_mfma_f32_16x16x32_bf16 v[140:143], v[64:67], v[88:91], v[140:143]
    ds_read_b128 v[92:95], v51 offset:10240
    v_mfma_f32_16x16x32_bf16 v[124:127], v[68:71], v[84:87], v[124:127]
    ds_read_b128 v[96:99], v51 offset:11264
    v_mfma_f32_16x16x32_bf16 v[144:147], v[68:71], v[88:91], v[144:147]
    ds_read_b128 v[100:103], v51 offset:12288
    s_waitcnt lgkmcnt(7)
    v_mfma_f32_16x16x32_bf16 v[128:131], v[72:75], v[84:87], v[128:131]
    ds_read_b128 v[104:107], v51 offset:13312
    v_mfma_f32_16x16x32_bf16 v[148:151], v[72:75], v[88:91], v[148:151]
    ds_read_b128 v[108:111], v51 offset:14336
    v_mfma_f32_16x16x32_bf16 v[132:135], v[76:79], v[84:87], v[132:135]
    v_add_u32 v51, s56, v48
    s_add_u32 s56, s56, 20480
    s_cmp_eq_u32 s56, 61440
    v_mfma_f32_16x16x32_bf16 v[152:155], v[76:79], v[88:91], v[152:155]
    s_cselect_b32 s56, 0, s56
    v_add_u32 v52, s57, v49
    v_add_u32 v53, s57, v50
    v_mfma_f32_16x16x32_bf16 v[136:139], v[80:83], v[84:87], v[136:139]
    s_add_u32 s57, s57, 8192
    s_cmp_eq_u32 s57, 90112
    s_cselect_b32 s57, 0, s57
    v_mfma_f32_16x16x32_bf16 v[156:159], v[80:83], v[88:91], v[156:159]
    s_add_u32 s65, s65, 1
    s_cmp_lt_u32 s65, 13
    s_cbranch_scc1 L_wv_cloop
    s_waitcnt lgkmcnt(0)
    v_mfma_f32_16x16x32_bf16 v[140:143], v[92:95], v[116:119], v[140:143]
    v_mfma_f32_16x16x32_bf16 v[144:147], v[96:99], v[116:119], v[144:147]
    v_mfma_f32_16x16x32_bf16 v[148:151], v[100:103], v[116:119], v[148:151]
    v_mfma_f32_16x16x32_bf16 v[152:155], v[104:107], v[116:119], v[152:155]
    v_mfma_f32_16x16x32_bf16 v[156:159], v[108:111], v[116:119], v[156:159]
    v_mfma_f32_16x16x32_bf16 v[120:123], v[92:95], v[112:115], v[120:123]
    v_mfma_f32_16x16x32_bf16 v[124:127], v[96:99], v[112:115], v[124:127]
    v_mfma_f32_16x16x32_bf16 v[128:131], v[100:103], v[112:115], v[128:131]
    v_mfma_f32_16x16x32_bf16 v[132:135], v[104:107], v[112:115], v[132:135]
    v_mfma_f32_16x16x32_bf16 v[136:139], v[108:111], v[112:115], v[136:139]
    s_nop 2
    ds_write_b128 v55, v[140:143] offset:0
    ds_write_b128 v55, v[144:147] offset:1024
    ds_write_b128 v55, v[148:151] offset:2048
    ds_write_b128 v55, v[152:155] offset:3072
    ds_write_b128 v55, v[156:159] offset:4096
    s_waitcnt lgkmcnt(0)
    s_barrier
    ds_read_b128 v[92:95], v56 offset:0
    ds_read_b128 v[96:99], v56 offset:1024
    ds_read_b128 v[100:103], v56 offset:2048
    ds_read_b128 v[104:107], v56 offset:3072
    ds_read_b128 v[108:111], v56 offset:4096
    s_waitcnt lgkmcnt(4)
    v_add_f32 v120, v120, v92
    v_add_f32 v121, v121, v93
    v_add_f32 v122, v122, v94
    v_add_f32 v123, v123, v95
    v_cvt_pk_bf16_f32 v64, v120, v121
    v_cvt_pk_bf16_f32 v65, v122, v123
    s_waitcnt lgkmcnt(3)
    v_add_f32 v124, v124, v96
    v_add_f32 v125, v125, v97
    v_add_f32 v126, v126, v98
    v_add_f32 v127, v127, v99
    v_cvt_pk_bf16_f32 v66, v124, v125
    v_cvt_pk_bf16_f32 v67, v126, v127
    s_nop 1
    v_permlane16_swap_b32 v64, v66
    v_permlane16_swap_b32 v65, v67
    buffer_store_dwordx4 v[64:67], v58, s[44:47], 0 offen sc1
    s_waitcnt lgkmcnt(2)
    v_add_f32 v128, v128, v100
    v_add_f32 v129, v129, v101
    v_add_f32 v130, v130, v102
    v_add_f32 v131, v131, v103
    v_cvt_pk_bf16_f32 v68, v128, v129
    v_cvt_pk_bf16_f32 v69, v130, v131
    s_waitcnt lgkmcnt(1)
    v_add_f32 v132, v132, v104
    v_add_f32 v133, v133, v105
    v_add_f32 v134, v134, v106
    v_add_f32 v135, v135, v107
    v_cvt_pk_bf16_f32 v70, v132, v133
    v_cvt_pk_bf16_f32 v71, v134, v135
    s_nop 1
    v_permlane16_swap_b32 v68, v70
    v_permlane16_swap_b32 v69, v71
    buffer_store_dwordx4 v[68:71], v59, s[44:47], 0 offen sc1
    s_waitcnt lgkmcnt(0)
    v_add_f32 v136, v136, v108
    v_add_f32 v137, v137, v109
    v_add_f32 v138, v138, v110
    v_add_f32 v139, v139, v111
    v_cvt_pk_bf16_f32 v72, v136, v137
    v_cvt_pk_bf16_f32 v73, v138, v139
    s_nop 1
    v_permlane16_swap_b32 v72, v74
    v_permlane16_swap_b32 v73, v75
    buffer_store_dwordx4 v[72:75], v60, s[44:47], 0 offen sc1
    s_branch L_c_cons
L_poll:
    s_mov_b32 exec_lo, -1
    s_mov_b32 exec_hi, 0
    s_mov_b32 s80, 0
L_poll_l:
    v_mov_b32 v30, 0
    buffer_atomic_or v30, v8, s[44:47], 0 offen sc0 sc1
    s_add_u32 s80, s80, 1
    s_cmp_ge_u32 s80, 524288
    s_cbranch_scc1 L_poll_l_done
    s_waitcnt vmcnt(0)
    v_readlane_b32 s59, v30, 31
    s_add_u32 s52, s59, 1540483477
    v_cmp_eq_u32 vcc, s52, v30
    s_mov_b32 s63, vcc_lo
    s_and_b32 s52, s63, s76
    s_cmp_eq_u32 s52, s76
    s_cbranch_scc0 L_poll_l
L_poll_l_done:
    s_mov_b64 exec, -1
L_poll_ret:
    s_setpc_b64 s[78:79]
L_xr:
    s_lshr_b32 s53, 0x0, s7
    s_and_b32 s53, s53, 0xff
    s_sub_u32 s6, s6, s52
    s_add_u32 s6, s6, s53
    s_mul_hi_u32 s60, s6, 0x33333334
    s_mul_i32 s5, s60, 5
    s_sub_u32 s5, s6, s5
    s_lshl_b32 s4, s4, 2
    s_add_u32 s4, s4, s60
    s_add_u32 s50, s60, s5
    s_and_b32 s50, s50, 3
    s_and_b32 s62, s3, 3
    s_cmp_lt_u32 s3, 4
    s_cbranch_scc1 L_xr_cons
    s_mov_b32 s66, 0x76532410
    s_mov_b32 s67, 0x98
    s_cmp_eq_u32 s50, 1
    s_cselect_b32 s66, 0x76405321, s66
    s_cselect_b32 s67, 0x98, s67
    s_cmp_eq_u32 s50, 2
    s_cselect_b32 s66, 0x75416032, s66
    s_cselect_b32 s67, 0x98, s67
    s_cmp_eq_u32 s50, 3
    s_cselect_b32 s66, 0x65472103, s66
    s_cselect_b32 s67, 0x98, s67
    v_lshrrev_b32 v28, 3, v0
    v_and_b32 v29, 7, v0
    v_lshrrev_b32 v30, 4, v0
    v_xor_b32 v29, v29, v30
    v_mul_u32_u24 v28, 1280, v28
    v_lshl_add_u32 v28, v29, 4, v28
    s_lshl_b32 s51, s4, 2
    s_add_u32 s51, s51, s62
    s_mul_i32 s52, s51, 81920
    v_add_u32 v4, s52, v28
    v_xor_b32 v5, 64, v4
    v_add_u32 v5, 10240, v5
    v_add_u32 v6, 20480, v4
    v_add_u32 v7, 20480, v5
    v_add_u32 v8, 20480, v6
    v_add_u32 v9, 20480, v7
    v_add_u32 v10, 20480, v8
    v_add_u32 v11, 20480, v9
    v_and_b32 v29, 15, v0
    v_lshlrev_b32 v31, 1, v30
    v_xor_b32 v29, v29, v31
    v_mul_u32_u24 v28, 1280, v30
    v_lshl_add_u32 v28, v29, 4, v28
    s_mul_i32 s52, s62, 20480
    s_lshl_b32 s53, s5, 8
    s_add_u32 s52, s52, s53
    v_add_u32 v12, s52, v28
    v_add_u32 v13, 5120, v12
    v_xor_b32 v14, 128, v12
    v_add_u32 v14, 10240, v14
    v_add_u32 v15, 5120, v14
    s_lshl_b32 s55, s62, 13
    s_lshl_b32 s56, s62, 12
    s_add_u32 s56, s56, 32768
    s_mov_b32 s60, 0
    s_mov_b32 s65, 0
    s_waitcnt lgkmcnt(0)
    s_mov_b32 s28, s8
    s_and_b32 s29, s9, 0xffff
    s_mov_b32 s30, 2621440
    s_mov_b32 s31, 0x00020000
    s_mov_b32 s32, s16
    s_and_b32 s33, s17, 0xffff
    s_mov_b32 s34, 819200
    s_mov_b32 s35, 0x00020000
L_xr_lloop:
    s_and_b32 s57, s66, 15
    s_lshr_b64 s[66:67], s[66:67], 4
    s_add_u32 m0, s56, s60
    s_lshl_b32 s58, s57, 7
    s_mul_i32 s59, s57, 81920
    buffer_load_dwordx4 v12, s[32:35], s59 offen lds
    s_add_u32 m0, m0, 1024
    s_nop 0
    buffer_load_dwordx4 v13, s[32:35], s59 offen lds
    s_add_u32 m0, m0, 1024
    s_nop 0
    buffer_load_dwordx4 v14, s[32:35], s59 offen lds
    s_add_u32 m0, m0, 1024
    s_nop 0
    buffer_load_dwordx4 v15, s[32:35], s59 offen lds
    s_add_u32 m0, s55, s60
    s_nop 0
    buffer_load_dwordx4 v4, s[28:31], s58 offen lds
    s_add_u32 m0, m0, 1024
    s_nop 0
    buffer_load_dwordx4 v5, s[28:31], s58 offen lds
    s_add_u32 m0, m0, 1024
    s_nop 0
    buffer_load_dwordx4 v6, s[28:31], s58 offen lds
    s_add_u32 m0, m0, 1024
    s_cmp_lg_u32 s65, 1
    s_cbranch_scc1 L_xr_ne
    s_waitcnt vmcnt(7)
    s_barrier
L_xr_ne:
    buffer_load_dwordx4 v7, s[28:31], s58 offen lds
    s_add_u32 m0, m0, 1024
    s_nop 0
    buffer_load_dwordx4 v8, s[28:31], s58 offen lds
    s_add_u32 m0, m0, 1024
    s_nop 0
    buffer_load_dwordx4 v9, s[28:31], s58 offen lds
    s_add_u32 m0, m0, 1024
    s_nop 0
    buffer_load_dwordx4 v10, s[28:31], s58 offen lds
    s_add_u32 m0, m0, 1024
    s_nop 0
    buffer_load_dwordx4 v11, s[28:31], s58 offen lds
    s_add_u32 s60, s60, 49152
    s_cmp_eq_u32 s60, 147456
    s_cselect_b32 s60, 0, s60
    s_add_u32 s65, s65, 1
    s_cmp_le_u32 s65, 2
    s_cbranch_scc1 L_xr_lloop
    s_waitcnt vmcnt(12)
    s_barrier
    s_cmp_lt_u32 s65, 10
    s_cbranch_scc1 L_xr_lloop
    s_waitcnt vmcnt(0)
    s_barrier
    s_mov_b32 s44, s24
    s_and_b32 s45, s25, 0xffff
    s_mov_b32 s46, 16777216
    s_mov_b32 s47, 0x00020000
    s_lshl_b32 s52, s4, 5
    v_add_u32 v16, s52, v0
    v_lshlrev_b32 v16, 8, v16
    v_add_u32 v16, 65536, v16
    v_mov_b32 v17, v16
    s_lshl_b32 s75, s5, 2
    s_add_u32 s75, s75, 96
    s_mov_b32 s74, -1
    s_mov_b32 s53, 4
    s_cmp_lg_u32 s3, 5
    s_cbranch_scc1 L_c_ld
    s_mov_b32 exec_hi, 0
    buffer_load_dword v19, v16, s[44:47], 0 offen offset:124 sc1
    s_mov_b64 exec, -1
    s_branch L_c_ld
L_xr_cons:
    s_and_b32 s61, s62, 1
    s_lshr_b32 s63, s62, 1
    v_and_b32 v28, 15, v0
    v_lshrrev_b32 v31, 4, v0
    v_bfe_u32 v29, v0, 1, 3
    v_xor_b32 v29, v29, v31
    v_lshlrev_b32 v29, 4, v29
    v_lshl_add_u32 v28, v28, 7, v29
    s_lshl_b32 s52, s61, 14
    v_add_u32 v4, s52, v28
    v_xor_b32 v5, 64, v4
    v_bfe_u32 v29, v0, 2, 2
    v_lshl_add_u32 v28, v31, 3, v29
    v_lshlrev_b32 v28, 8, v28
    v_bfe_u32 v29, v0, 2, 3
    s_lshl_b32 s52, s63, 2
    v_xor_b32 v29, s52, v29
    v_lshl_add_u32 v28, v29, 5, v28
    v_and_b32 v29, 3, v0
    v_lshl_add_u32 v28, v29, 3, v28
    v_add_u32 v6, 32768, v28
    v_xor_b32 v7, 32, v6
    v_xor_b32 v8, 64, v6
    v_xor_b32 v9, 96, v6
    s_lshl_b32 s54, s4, 1
    s_add_u32 s54, s54, s61
    s_mul_i32 s52, s54, 163840
    s_add_u32 s52, s52, 4718592
    s_lshl_b32 s53, s5, 1
    s_add_u32 s53, s53, s63
    s_lshl_b32 s53, s53, 14
    s_add_u32 s52, s52, s53
    v_and_b32 v28, 15, v0
    v_bfe_u32 v29, v0, 4, 1
    v_lshl_add_u32 v28, v29, 5, v28
    v_lshrrev_b32 v29, 5, v0
    v_lshl_add_u32 v28, v29, 4, v28
    v_lshl_add_u32 v16, v28, 4, s52
    s_mov_b32 s68, 4096
    s_mov_b32 s69, 8192
    s_mov_b32 s70, 12288
    v_mov_b32 v128, 0
    v_mov_b32 v129, 0
    v_mov_b32 v130, 0
    v_mov_b32 v131, 0
    v_mov_b32 v132, 0
    v_mov_b32 v133, 0
    v_mov_b32 v134, 0
    v_mov_b32 v135, 0
    v_mov_b32 v136, 0
    v_mov_b32 v137, 0
    v_mov_b32 v138, 0
    v_mov_b32 v139, 0
    v_mov_b32 v140, 0
    v_mov_b32 v141, 0
    v_mov_b32 v142, 0
    v_mov_b32 v143, 0
    v_mov_b32 v144, 0
    v_mov_b32 v145, 0
    v_mov_b32 v146, 0
    v_mov_b32 v147, 0
    v_mov_b32 v148, 0
    v_mov_b32 v149, 0
    v_mov_b32 v150, 0
    v_mov_b32 v151, 0
    v_mov_b32 v152, 0
    v_mov_b32 v153, 0
    v_mov_b32 v154, 0
    v_mov_b32 v155, 0
    v_mov_b32 v156, 0
    v_mov_b32 v157, 0
    v_mov_b32 v158, 0
    v_mov_b32 v159, 0
    v_mov_b32 v160, 0
    v_mov_b32 v161, 0
    v_mov_b32 v162, 0
    v_mov_b32 v163, 0
    v_mov_b32 v164, 0
    v_mov_b32 v165, 0
    v_mov_b32 v166, 0
    v_mov_b32 v167, 0
    v_mov_b32 v168, 0
    v_mov_b32 v169, 0
    v_mov_b32 v170, 0
    v_mov_b32 v171, 0
    v_mov_b32 v172, 0
    v_mov_b32 v173, 0
    v_mov_b32 v174, 0
    v_mov_b32 v175, 0
    v_mov_b32 v176, 0
    v_mov_b32 v177, 0
    v_mov_b32 v178, 0
    v_mov_b32 v179, 0
    v_mov_b32 v180, 0
    v_mov_b32 v181, 0
    v_mov_b32 v182, 0
    v_mov_b32 v183, 0
    v_mov_b32 v184, 0
    v_mov_b32 v185, 0
    v_mov_b32 v186, 0
    v_mov_b32 v187, 0
    v_mov_b32 v188, 0
    v_mov_b32 v189, 0
    v_mov_b32 v190, 0
    v_mov_b32 v191, 0
    v_mov_b32 v192, 0
    v_mov_b32 v193, 0
    v_mov_b32 v194, 0
    v_mov_b32 v195, 0
    v_mov_b32 v196, 0
    v_mov_b32 v197, 0
    v_mov_b32 v198, 0
    v_mov_b32 v199, 0
    v_mov_b32 v200, 0
    v_mov_b32 v201, 0
    v_mov_b32 v202, 0
    v_mov_b32 v203, 0
    v_mov_b32 v204, 0
    v_mov_b32 v205, 0
    v_mov_b32 v206, 0
    v_mov_b32 v207, 0
    v_mov_b32 v208, 0
    v_mov_b32 v209, 0
    v_mov_b32 v210, 0
    v_mov_b32 v211, 0
    v_mov_b32 v212, 0
    v_mov_b32 v213, 0
    v_mov_b32 v214, 0
    v_mov_b32 v215, 0
    v_mov_b32 v216, 0
    v_mov_b32 v217, 0
    v_mov_b32 v218, 0
    v_mov_b32 v219, 0
    v_mov_b32 v220, 0
    v_mov_b32 v221, 0
    v_mov_b32 v222, 0
    v_mov_b32 v223, 0
    v_mov_b32 v224, 0
    v_mov_b32 v225, 0
    v_mov_b32 v226, 0
    v_mov_b32 v227, 0
    v_mov_b32 v228, 0
    v_mov_b32 v229, 0
    v_mov_b32 v230, 0
    v_mov_b32 v231, 0
    v_mov_b32 v232, 0
    v_mov_b32 v233, 0
    v_mov_b32 v234, 0
    v_mov_b32 v235, 0
    v_mov_b32 v236, 0
    v_mov_b32 v237, 0
    v_mov_b32 v238, 0
    v_mov_b32 v239, 0
    v_mov_b32 v240, 0
    v_mov_b32 v241, 0
    v_mov_b32 v242, 0
    v_mov_b32 v243, 0
    v_mov_b32 v244, 0
    v_mov_b32 v245, 0
    v_mov_b32 v246, 0
    v_mov_b32 v247, 0
    v_mov_b32 v248, 0
    v_mov_b32 v249, 0
    v_mov_b32 v250, 0
    v_mov_b32 v251, 0
    v_mov_b32 v252, 0
    v_mov_b32 v253, 0
    v_mov_b32 v254, 0
    v_mov_b32 v255, 0
    s_waitcnt lgkmcnt(0)
    s_mov_b32 s44, s24
    s_and_b32 s45, s25, 0xffff
    s_mov_b32 s46, 16777216
    s_mov_b32 s47, 0x00020000
    s_mov_b32 s64, 0
    s_mov_b32 s65, 0
    v_add_u32 v10, s64, v4
    v_add_u32 v11, s64, v5
    v_add_u32 v12, s64, v6
    v_add_u32 v13, s64, v7
    v_add_u32 v14, s64, v8
    v_add_u32 v15, s64, v9
    s_add_u32 s64, s64, 49152
    s_cmp_eq_u32 s64, 147456
    s_cselect_b32 s64, 0, s64
    s_barrier
    ds_read_b64_tr_b16 v[64:65], v12 offset:0
    ds_read_b64_tr_b16 v[66:67], v12 offset:1024
    ds_read_b64_tr_b16 v[68:69], v13 offset:0
    ds_read_b64_tr_b16 v[70:71], v13 offset:1024
    ds_read_b64_tr_b16 v[72:73], v14 offset:0
    ds_read_b64_tr_b16 v[74:75], v14 offset:1024
    ds_read_b64_tr_b16 v[76:77], v15 offset:0
    ds_read_b64_tr_b16 v[78:79], v15 offset:1024
    ds_read_b128 v[32:35], v10 offset:0
    ds_read_b128 v[36:39], v10 offset:2048
    ds_read_b128 v[40:43], v10 offset:4096
    ds_read_b128 v[44:47], v10 offset:6144
    ds_read_b128 v[48:51], v10 offset:8192
    ds_read_b128 v[52:55], v10 offset:10240
    ds_read_b128 v[56:59], v10 offset:12288
    ds_read_b128 v[60:63], v10 offset:14336
L_xr_cloop:
    s_waitcnt lgkmcnt(0)
    v_mfma_f32_16x16x32_bf16 v[128:131], v[64:67], v[32:35], v[128:131]
    ds_read_b64_tr_b16 v[112:113], v12 offset:8192
    v_mfma_f32_16x16x32_bf16 v[132:135], v[68:71], v[32:35], v[132:135]
    ds_read_b64_tr_b16 v[114:115], v12 offset:9216
    v_mfma_f32_16x16x32_bf16 v[136:139], v[72:75], v[32:35], v[136:139]
    ds_read_b64_tr_b16 v[116:117], v13 offset:8192
    v_mfma_f32_16x16x32_bf16 v[140:143], v[76:79], v[32:35], v[140:143]
    ds_read_b64_tr_b16 v[118:119], v13 offset:9216
    v_mfma_f32_16x16x32_bf16 v[144:147], v[64:67], v[36:39], v[144:147]
    ds_read_b64_tr_b16 v[120:121], v14 offset:8192
    v_mfma_f32_16x16x32_bf16 v[148:151], v[68:71], v[36:39], v[148:151]
    ds_read_b64_tr_b16 v[122:123], v14 offset:9216
    v_mfma_f32_16x16x32_bf16 v[152:155], v[72:75], v[36:39], v[152:155]
    ds_read_b64_tr_b16 v[124:125], v15 offset:8192
    v_mfma_f32_16x16x32_bf16 v[156:159], v[76:79], v[36:39], v[156:159]
    ds_read_b64_tr_b16 v[126:127], v15 offset:9216
    v_mfma_f32_16x16x32_bf16 v[160:163], v[64:67], v[40:43], v[160:163]
    ds_read_b128 v[80:83], v11 offset:0
    v_mfma_f32_16x16x32_bf16 v[164:167], v[68:71], v[40:43], v[164:167]
    ds_read_b128 v[84:87], v11 offset:2048
    v_mfma_f32_16x16x32_bf16 v[168:171], v[72:75], v[40:43], v[168:171]
    ds_read_b128 v[88:91], v11 offset:4096
    v_mfma_f32_16x16x32_bf16 v[172:175], v[76:79], v[40:43], v[172:175]
    ds_read_b128 v[92:95], v11 offset:6144
    v_mfma_f32_16x16x32_bf16 v[176:179], v[64:67], v[44:47], v[176:179]
    ds_read_b128 v[96:99], v11 offset:8192
    v_mfma_f32_16x16x32_bf16 v[180:183], v[68:71], v[44:47], v[180:183]
    ds_read_b128 v[100:103], v11 offset:10240
    v_mfma_f32_16x16x32_bf16 v[184:187], v[72:75], v[44:47], v[184:187]
    ds_read_b128 v[104:107], v11 offset:12288
    v_mfma_f32_16x16x32_bf16 v[188:191], v[76:79], v[44:47], v[188:191]
    ds_read_b128 v[108:111], v11 offset:14336
    v_mfma_f32_16x16x32_bf16 v[192:195], v[64:67], v[48:51], v[192:195]
    v_add_u32 v10, s64, v4
    v_mfma_f32_16x16x32_bf16 v[196:199], v[68:71], v[48:51], v[196:199]
    v_add_u32 v11, s64, v5
    v_mfma_f32_16x16x32_bf16 v[200:203], v[72:75], v[48:51], v[200:203]
    v_add_u32 v12, s64, v6
    v_mfma_f32_16x16x32_bf16 v[204:207], v[76:79], v[48:51], v[204:207]
    v_add_u32 v13, s64, v7
    v_mfma_f32_16x16x32_bf16 v[208:211], v[64:67], v[52:55], v[208:211]
    v_add_u32 v14, s64, v8
    v_mfma_f32_16x16x32_bf16 v[212:215], v[68:71], v[52:55], v[212:215]
    v_add_u32 v15, s64, v9
    v_mfma_f32_16x16x32_bf16 v[216:219], v[72:75], v[52:55], v[216:219]
    s_add_u32 s64, s64, 49152
    v_mfma_f32_16x16x32_bf16 v[220:223], v[76:79], v[52:55], v[220:223]
    s_cmp_eq_u32 s64, 147456
    v_mfma_f32_16x16x32_bf16 v[224:227], v[64:67], v[56:59], v[224:227]
    s_cselect_b32 s64, 0, s64
    v_mfma_f32_16x16x32_bf16 v[228:231], v[68:71], v[56:59], v[228:231]
    s_add_u32 s65, s65, 1
    v_mfma_f32_16x16x32_bf16 v[232:235], v[72:75], v[56:59], v[232:235]
    s_cmp_eq_u32 s65, 8
    v_mfma_f32_16x16x32_bf16 v[236:239], v[76:79], v[56:59], v[236:239]
    v_mfma_f32_16x16x32_bf16 v[240:243], v[64:67], v[60:63], v[240:243]
    v_mfma_f32_16x16x32_bf16 v[244:247], v[68:71], v[60:63], v[244:247]
    v_mfma_f32_16x16x32_bf16 v[248:251], v[72:75], v[60:63], v[248:251]
    v_mfma_f32_16x16x32_bf16 v[252:255], v[76:79], v[60:63], v[252:255]
    s_waitcnt lgkmcnt(0)
    s_barrier
    s_cbranch_scc1 L_xr_tail
    v_mfma_f32_16x16x32_bf16 v[128:131], v[112:115], v[80:83], v[128:131]
    ds_read_b64_tr_b16 v[64:65], v12 offset:0
    v_mfma_f32_16x16x32_bf16 v[132:135], v[116:119], v[80:83], v[132:135]
    ds_read_b64_tr_b16 v[66:67], v12 offset:1024
    v_mfma_f32_16x16x32_bf16 v[136:139], v[120:123], v[80:83], v[136:139]
    ds_read_b64_tr_b16 v[68:69], v13 offset:0
    v_mfma_f32_16x16x32_bf16 v[140:143], v[124:127], v[80:83], v[140:143]
    ds_read_b64_tr_b16 v[70:71], v13 offset:1024
    v_mfma_f32_16x16x32_bf16 v[144:147], v[112:115], v[84:87], v[144:147]
    ds_read_b64_tr_b16 v[72:73], v14 offset:0
    v_mfma_f32_16x16x32_bf16 v[148:151], v[116:119], v[84:87], v[148:151]
    ds_read_b64_tr_b16 v[74:75], v14 offset:1024
    v_mfma_f32_16x16x32_bf16 v[152:155], v[120:123], v[84:87], v[152:155]
    ds_read_b64_tr_b16 v[76:77], v15 offset:0
    v_mfma_f32_16x16x32_bf16 v[156:159], v[124:127], v[84:87], v[156:159]
    ds_read_b64_tr_b16 v[78:79], v15 offset:1024
    v_mfma_f32_16x16x32_bf16 v[160:163], v[112:115], v[88:91], v[160:163]
    ds_read_b128 v[32:35], v10 offset:0
    v_mfma_f32_16x16x32_bf16 v[164:167], v[116:119], v[88:91], v[164:167]
    ds_read_b128 v[36:39], v10 offset:2048
    v_mfma_f32_16x16x32_bf16 v[168:171], v[120:123], v[88:91], v[168:171]
    ds_read_b128 v[40:43], v10 offset:4096
    v_mfma_f32_16x16x32_bf16 v[172:175], v[124:127], v[88:91], v[172:175]
    ds_read_b128 v[44:47], v10 offset:6144
    v_mfma_f32_16x16x32_bf16 v[176:179], v[112:115], v[92:95], v[176:179]
    ds_read_b128 v[48:51], v10 offset:8192
    v_mfma_f32_16x16x32_bf16 v[180:183], v[116:119], v[92:95], v[180:183]
    ds_read_b128 v[52:55], v10 offset:10240
    v_mfma_f32_16x16x32_bf16 v[184:187], v[120:123], v[92:95], v[184:187]
    ds_read_b128 v[56:59], v10 offset:12288
    v_mfma_f32_16x16x32_bf16 v[188:191], v[124:127], v[92:95], v[188:191]
    ds_read_b128 v[60:63], v10 offset:14336
    v_mfma_f32_16x16x32_bf16 v[192:195], v[112:115], v[96:99], v[192:195]
    v_mfma_f32_16x16x32_bf16 v[196:199], v[116:119], v[96:99], v[196:199]
    v_mfma_f32_16x16x32_bf16 v[200:203], v[120:123], v[96:99], v[200:203]
    v_mfma_f32_16x16x32_bf16 v[204:207], v[124:127], v[96:99], v[204:207]
    v_mfma_f32_16x16x32_bf16 v[208:211], v[112:115], v[100:103], v[208:211]
    v_mfma_f32_16x16x32_bf16 v[212:215], v[116:119], v[100:103], v[212:215]
    v_mfma_f32_16x16x32_bf16 v[216:219], v[120:123], v[100:103], v[216:219]
    v_mfma_f32_16x16x32_bf16 v[220:223], v[124:127], v[100:103], v[220:223]
    v_mfma_f32_16x16x32_bf16 v[224:227], v[112:115], v[104:107], v[224:227]
    v_mfma_f32_16x16x32_bf16 v[228:231], v[116:119], v[104:107], v[228:231]
    v_mfma_f32_16x16x32_bf16 v[232:235], v[120:123], v[104:107], v[232:235]
    v_mfma_f32_16x16x32_bf16 v[236:239], v[124:127], v[104:107], v[236:239]
    v_mfma_f32_16x16x32_bf16 v[240:243], v[112:115], v[108:111], v[240:243]
    v_mfma_f32_16x16x32_bf16 v[244:247], v[116:119], v[108:111], v[244:247]
    v_mfma_f32_16x16x32_bf16 v[248:251], v[120:123], v[108:111], v[248:251]
    v_mfma_f32_16x16x32_bf16 v[252:255], v[124:127], v[108:111], v[252:255]
    s_branch L_xr_cloop
L_xr_tail:
    v_mfma_f32_16x16x32_bf16 v[128:131], v[112:115], v[80:83], v[128:131]
    ds_read_b64_tr_b16 v[32:33], v12 offset:0
    v_mfma_f32_16x16x32_bf16 v[132:135], v[116:119], v[80:83], v[132:135]
    ds_read_b64_tr_b16 v[34:35], v12 offset:1024
    v_mfma_f32_16x16x32_bf16 v[136:139], v[120:123], v[80:83], v[136:139]
    ds_read_b64_tr_b16 v[36:37], v13 offset:0
    v_mfma_f32_16x16x32_bf16 v[140:143], v[124:127], v[80:83], v[140:143]
    ds_read_b64_tr_b16 v[38:39], v13 offset:1024
    v_mfma_f32_16x16x32_bf16 v[144:147], v[112:115], v[84:87], v[144:147]
    ds_read_b64_tr_b16 v[40:41], v14 offset:0
    v_mfma_f32_16x16x32_bf16 v[148:151], v[116:119], v[84:87], v[148:151]
    ds_read_b64_tr_b16 v[42:43], v14 offset:1024
    v_mfma_f32_16x16x32_bf16 v[152:155], v[120:123], v[84:87], v[152:155]
    ds_read_b64_tr_b16 v[44:45], v15 offset:0
    v_mfma_f32_16x16x32_bf16 v[156:159], v[124:127], v[84:87], v[156:159]
    ds_read_b64_tr_b16 v[46:47], v15 offset:1024
    v_mfma_f32_16x16x32_bf16 v[160:163], v[112:115], v[88:91], v[160:163]
    ds_read_b128 v[20:23], v10 offset:0
    v_mfma_f32_16x16x32_bf16 v[164:167], v[116:119], v[88:91], v[164:167]
    ds_read_b64_tr_b16 v[48:49], v12 offset:8192
    v_mfma_f32_16x16x32_bf16 v[168:171], v[120:123], v[88:91], v[168:171]
    ds_read_b64_tr_b16 v[50:51], v12 offset:9216
    v_mfma_f32_16x16x32_bf16 v[172:175], v[124:127], v[88:91], v[172:175]
    ds_read_b64_tr_b16 v[52:53], v13 offset:8192
    v_mfma_f32_16x16x32_bf16 v[176:179], v[112:115], v[92:95], v[176:179]
    ds_read_b64_tr_b16 v[54:55], v13 offset:9216
    v_mfma_f32_16x16x32_bf16 v[180:183], v[116:119], v[92:95], v[180:183]
    ds_read_b64_tr_b16 v[56:57], v14 offset:8192
    v_mfma_f32_16x16x32_bf16 v[184:187], v[120:123], v[92:95], v[184:187]
    ds_read_b64_tr_b16 v[58:59], v14 offset:9216
    v_mfma_f32_16x16x32_bf16 v[188:191], v[124:127], v[92:95], v[188:191]
    ds_read_b64_tr_b16 v[60:61], v15 offset:8192
    v_mfma_f32_16x16x32_bf16 v[192:195], v[112:115], v[96:99], v[192:195]
    ds_read_b64_tr_b16 v[62:63], v15 offset:9216
    v_mfma_f32_16x16x32_bf16 v[196:199], v[116:119], v[96:99], v[196:199]
    ds_read_b128 v[24:27], v11 offset:0
    v_mfma_f32_16x16x32_bf16 v[200:203], v[120:123], v[96:99], v[200:203]
    v_mfma_f32_16x16x32_bf16 v[204:207], v[124:127], v[96:99], v[204:207]
    s_barrier
    v_mfma_f32_16x16x32_bf16 v[208:211], v[112:115], v[100:103], v[208:211]
    ds_read_b64_tr_b16 v[64:65], v6 offset:0
    v_mfma_f32_16x16x32_bf16 v[212:215], v[116:119], v[100:103], v[212:215]
    ds_read_b64_tr_b16 v[66:67], v6 offset:1024
    v_mfma_f32_16x16x32_bf16 v[216:219], v[120:123], v[100:103], v[216:219]
    ds_read_b64_tr_b16 v[68:69], v7 offset:0
    v_mfma_f32_16x16x32_bf16 v[220:223], v[124:127], v[100:103], v[220:223]
    ds_read_b64_tr_b16 v[70:71], v7 offset:1024
    v_mfma_f32_16x16x32_bf16 v[224:227], v[112:115], v[104:107], v[224:227]
    ds_read_b64_tr_b16 v[72:73], v8 offset:0
    v_mfma_f32_16x16x32_bf16 v[228:231], v[116:119], v[104:107], v[228:231]
    ds_read_b64_tr_b16 v[74:75], v8 offset:1024
    v_mfma_f32_16x16x32_bf16 v[232:235], v[120:123], v[104:107], v[232:235]
    ds_read_b64_tr_b16 v[76:77], v9 offset:0
    v_mfma_f32_16x16x32_bf16 v[236:239], v[124:127], v[104:107], v[236:239]
    ds_read_b64_tr_b16 v[78:79], v9 offset:1024
    v_mfma_f32_16x16x32_bf16 v[240:243], v[112:115], v[108:111], v[240:243]
    v_mfma_f32_16x16x32_bf16 v[244:247], v[116:119], v[108:111], v[244:247]
    v_mfma_f32_16x16x32_bf16 v[248:251], v[120:123], v[108:111], v[248:251]
    v_mfma_f32_16x16x32_bf16 v[252:255], v[124:127], v[108:111], v[252:255]
    ds_read_b128 v[96:99], v4 offset:0
    ds_read_b64_tr_b16 v[80:81], v6 offset:8192
    ds_read_b64_tr_b16 v[82:83], v6 offset:9216
    ds_read_b64_tr_b16 v[84:85], v7 offset:8192
    ds_read_b64_tr_b16 v[86:87], v7 offset:9216
    ds_read_b64_tr_b16 v[88:89], v8 offset:8192
    ds_read_b64_tr_b16 v[90:91], v8 offset:9216
    ds_read_b64_tr_b16 v[92:93], v9 offset:8192
    ds_read_b64_tr_b16 v[94:95], v9 offset:9216
    ds_read_b128 v[100:103], v5 offset:0
    ds_read_b128 v[104:107], v10 offset:2048
    ds_read_b128 v[108:111], v11 offset:2048
    s_waitcnt lgkmcnt(15)
    v_mfma_f32_16x16x32_bf16 v[128:131], v[32:35], v[20:23], v[128:131]
    v_mfma_f32_16x16x32_bf16 v[132:135], v[36:39], v[20:23], v[132:135]
    v_mfma_f32_16x16x32_bf16 v[136:139], v[40:43], v[20:23], v[136:139]
    v_mfma_f32_16x16x32_bf16 v[140:143], v[44:47], v[20:23], v[140:143]
    ds_read_b128 v[112:115], v4 offset:2048
    s_waitcnt lgkmcnt(15)
    v_mfma_f32_16x16x32_bf16 v[128:131], v[48:51], v[24:27], v[128:131]
    v_mfma_f32_16x16x32_bf16 v[132:135], v[52:55], v[24:27], v[132:135]
    v_mfma_f32_16x16x32_bf16 v[136:139], v[56:59], v[24:27], v[136:139]
    v_mfma_f32_16x16x32_bf16 v[140:143], v[60:63], v[24:27], v[140:143]
    ds_read_b128 v[116:119], v5 offset:2048
    s_waitcnt lgkmcnt(13)
    v_mfma_f32_16x16x32_bf16 v[128:131], v[64:67], v[96:99], v[128:131]
    v_mfma_f32_16x16x32_bf16 v[132:135], v[68:71], v[96:99], v[132:135]
    v_mfma_f32_16x16x32_bf16 v[136:139], v[72:75], v[96:99], v[136:139]
    v_mfma_f32_16x16x32_bf16 v[140:143], v[76:79], v[96:99], v[140:143]
    ds_read_b128 v[20:23], v10 offset:4096
    s_waitcnt lgkmcnt(5)
    v_mfma_f32_16x16x32_bf16 v[128:131], v[80:83], v[100:103], v[128:131]
    v_mfma_f32_16x16x32_bf16 v[132:135], v[84:87], v[100:103], v[132:135]
    v_mfma_f32_16x16x32_bf16 v[136:139], v[88:91], v[100:103], v[136:139]
    v_mfma_f32_16x16x32_bf16 v[140:143], v[92:95], v[100:103], v[140:143]
    ds_read_b128 v[24:27], v11 offset:4096
    s_waitcnt lgkmcnt(5)
    v_mfma_f32_16x16x32_bf16 v[144:147], v[32:35], v[104:107], v[144:147]
    v_mfma_f32_16x16x32_bf16 v[148:151], v[36:39], v[104:107], v[148:151]
    v_mfma_f32_16x16x32_bf16 v[152:155], v[40:43], v[104:107], v[152:155]
    v_mfma_f32_16x16x32_bf16 v[156:159], v[44:47], v[104:107], v[156:159]
    ds_read_b128 v[96:99], v4 offset:4096
    s_waitcnt lgkmcnt(5)
    v_mfma_f32_16x16x32_bf16 v[144:147], v[48:51], v[108:111], v[144:147]
    v_mfma_f32_16x16x32_bf16 v[148:151], v[52:55], v[108:111], v[148:151]
    v_mfma_f32_16x16x32_bf16 v[152:155], v[56:59], v[108:111], v[152:155]
    v_cvt_pk_bf16_f32 v120, v128, v129
    v_cvt_pk_bf16_f32 v121, v130, v131
    v_mfma_f32_16x16x32_bf16 v[156:159], v[60:63], v[108:111], v[156:159]
    v_cvt_pk_bf16_f32 v122, v132, v133
    v_cvt_pk_bf16_f32 v123, v134, v135
    ds_read_b128 v[100:103], v5 offset:4096
    s_waitcnt lgkmcnt(5)
    v_mfma_f32_16x16x32_bf16 v[144:147], v[64:67], v[112:115], v[144:147]
    v_mfma_f32_16x16x32_bf16 v[148:151], v[68:71], v[112:115], v[148:151]
    v_permlane16_swap_b32 v120, v122
    v_permlane16_swap_b32 v121, v123
    v_mfma_f32_16x16x32_bf16 v[152:155], v[72:75], v[112:115], v[152:155]
    buffer_store_dwordx4 v[120:123], v16, s[44:47], 0 offen offset:0 sc1
    v_cvt_pk_bf16_f32 v124, v136, v137
    v_mfma_f32_16x16x32_bf16 v[156:159], v[76:79], v[112:115], v[156:159]
    v_cvt_pk_bf16_f32 v125, v138, v139
    v_cvt_pk_bf16_f32 v126, v140, v141
    ds_read_b128 v[104:107], v10 offset:6144
    s_waitcnt lgkmcnt(5)
    v_mfma_f32_16x16x32_bf16 v[144:147], v[80:83], v[116:119], v[144:147]
    v_cvt_pk_bf16_f32 v127, v142, v143
    v_mfma_f32_16x16x32_bf16 v[148:151], v[84:87], v[116:119], v[148:151]
    v_permlane16_swap_b32 v124, v126
    v_mfma_f32_16x16x32_bf16 v[152:155], v[88:91], v[116:119], v[152:155]
    v_permlane16_swap_b32 v125, v127
    buffer_store_dwordx4 v[124:127], v16, s[44:47], s69 offen offset:0 sc1
    v_mfma_f32_16x16x32_bf16 v[156:159], v[92:95], v[116:119], v[156:159]
    ds_read_b128 v[108:111], v11 offset:6144
    s_waitcnt lgkmcnt(5)
    v_mfma_f32_16x16x32_bf16 v[160:163], v[32:35], v[20:23], v[160:163]
    v_mfma_f32_16x16x32_bf16 v[164:167], v[36:39], v[20:23], v[164:167]
    v_mfma_f32_16x16x32_bf16 v[168:171], v[40:43], v[20:23], v[168:171]
    v_mfma_f32_16x16x32_bf16 v[172:175], v[44:47], v[20:23], v[172:175]
    ds_read_b128 v[112:115], v4 offset:6144
    s_waitcnt lgkmcnt(5)
    v_mfma_f32_16x16x32_bf16 v[160:163], v[48:51], v[24:27], v[160:163]
    v_mfma_f32_16x16x32_bf16 v[164:167], v[52:55], v[24:27], v[164:167]
    v_mfma_f32_16x16x32_bf16 v[168:171], v[56:59], v[24:27], v[168:171]
    v_cvt_pk_bf16_f32 v120, v144, v145
    v_cvt_pk_bf16_f32 v121, v146, v147
    v_mfma_f32_16x16x32_bf16 v[172:175], v[60:63], v[24:27], v[172:175]
    v_cvt_pk_bf16_f32 v122, v148, v149
    v_cvt_pk_bf16_f32 v123, v150, v151
    ds_read_b128 v[116:119], v5 offset:6144
    s_waitcnt lgkmcnt(5)
    v_mfma_f32_16x16x32_bf16 v[160:163], v[64:67], v[96:99], v[160:163]
    v_mfma_f32_16x16x32_bf16 v[164:167], v[68:71], v[96:99], v[164:167]
    v_permlane16_swap_b32 v120, v122
    v_permlane16_swap_b32 v121, v123
    v_mfma_f32_16x16x32_bf16 v[168:171], v[72:75], v[96:99], v[168:171]
    buffer_store_dwordx4 v[120:123], v16, s[44:47], 0 offen offset:1024 sc1
    v_cvt_pk_bf16_f32 v124, v152, v153
    v_mfma_f32_16x16x32_bf16 v[172:175], v[76:79], v[96:99], v[172:175]
    v_cvt_pk_bf16_f32 v125, v154, v155
    v_cvt_pk_bf16_f32 v126, v156, v157
    ds_read_b128 v[20:23], v10 offset:8192
    s_waitcnt lgkmcnt(5)
    v_mfma_f32_16x16x32_bf16 v[160:163], v[80:83], v[100:103], v[160:163]
    v_cvt_pk_bf16_f32 v127, v158, v159
    v_mfma_f32_16x16x32_bf16 v[164:167], v[84:87], v[100:103], v[164:167]
    v_permlane16_swap_b32 v124, v126
    v_mfma_f32_16x16x32_bf16 v[168:171], v[88:91], v[100:103], v[168:171]
    v_permlane16_swap_b32 v125, v127
    buffer_store_dwordx4 v[124:127], v16, s[44:47], s69 offen offset:1024 sc1
    v_mfma_f32_16x16x32_bf16 v[172:175], v[92:95], v[100:103], v[172:175]
    ds_read_b128 v[24:27], v11 offset:8192
    s_waitcnt lgkmcnt(5)
    v_mfma_f32_16x16x32_bf16 v[176:179], v[32:35], v[104:107], v[176:179]
    v_mfma_f32_16x16x32_bf16 v[180:183], v[36:39], v[104:107], v[180:183]
    v_mfma_f32_16x16x32_bf16 v[184:187], v[40:43], v[104:107], v[184:187]
    v_mfma_f32_16x16x32_bf16 v[188:191], v[44:47], v[104:107], v[188:191]
    ds_read_b128 v[96:99], v4 offset:8192
    s_waitcnt lgkmcnt(5)
    v_mfma_f32_16x16x32_bf16 v[176:179], v[48:51], v[108:111], v[176:179]
    v_mfma_f32_16x16x32_bf16 v[180:183], v[52:55], v[108:111], v[180:183]
    v_mfma_f32_16x16x32_bf16 v[184:187], v[56:59], v[108:111], v[184:187]
    v_cvt_pk_bf16_f32 v120, v160, v161
    v_cvt_pk_bf16_f32 v121, v162, v163
    v_mfma_f32_16x16x32_bf16 v[188:191], v[60:63], v[108:111], v[188:191]
    v_cvt_pk_bf16_f32 v122, v164, v165
    v_cvt_pk_bf16_f32 v123, v166, v167
    ds_read_b128 v[100:103], v5 offset:8192
    s_waitcnt lgkmcnt(5)
    v_mfma_f32_16x16x32_bf16 v[176:179], v[64:67], v[112:115], v[176:179]
    v_mfma_f32_16x16x32_bf16 v[180:183], v[68:71], v[112:115], v[180:183]
    v_permlane16_swap_b32 v120, v122
    v_permlane16_swap_b32 v121, v123
    v_mfma_f32_16x16x32_bf16 v[184:187], v[72:75], v[112:115], v[184:187]
    buffer_store_dwordx4 v[120:123], v16, s[44:47], 0 offen offset:2048 sc1
    v_cvt_pk_bf16_f32 v124, v168, v169
    v_mfma_f32_16x16x32_bf16 v[188:191], v[76:79], v[112:115], v[188:191]
    v_cvt_pk_bf16_f32 v125, v170, v171
    v_cvt_pk_bf16_f32 v126, v172, v173
    ds_read_b128 v[104:107], v10 offset:10240
    s_waitcnt lgkmcnt(5)
    v_mfma_f32_16x16x32_bf16 v[176:179], v[80:83], v[116:119], v[176:179]
    v_cvt_pk_bf16_f32 v127, v174, v175
    v_mfma_f32_16x16x32_bf16 v[180:183], v[84:87], v[116:119], v[180:183]
    v_permlane16_swap_b32 v124, v126
    v_mfma_f32_16x16x32_bf16 v[184:187], v[88:91], v[116:119], v[184:187]
    v_permlane16_swap_b32 v125, v127
    buffer_store_dwordx4 v[124:127], v16, s[44:47], s69 offen offset:2048 sc1
    v_mfma_f32_16x16x32_bf16 v[188:191], v[92:95], v[116:119], v[188:191]
    ds_read_b128 v[108:111], v11 offset:10240
    s_waitcnt lgkmcnt(5)
    v_mfma_f32_16x16x32_bf16 v[192:195], v[32:35], v[20:23], v[192:195]
    v_mfma_f32_16x16x32_bf16 v[196:199], v[36:39], v[20:23], v[196:199]
    v_mfma_f32_16x16x32_bf16 v[200:203], v[40:43], v[20:23], v[200:203]
    v_mfma_f32_16x16x32_bf16 v[204:207], v[44:47], v[20:23], v[204:207]
    ds_read_b128 v[112:115], v4 offset:10240
    s_waitcnt lgkmcnt(5)
    v_mfma_f32_16x16x32_bf16 v[192:195], v[48:51], v[24:27], v[192:195]
    v_mfma_f32_16x16x32_bf16 v[196:199], v[52:55], v[24:27], v[196:199]
    v_mfma_f32_16x16x32_bf16 v[200:203], v[56:59], v[24:27], v[200:203]
    v_cvt_pk_bf16_f32 v120, v176, v177
    v_cvt_pk_bf16_f32 v121, v178, v179
    v_mfma_f32_16x16x32_bf16 v[204:207], v[60:63], v[24:27], v[204:207]
    v_cvt_pk_bf16_f32 v122, v180, v181
    v_cvt_pk_bf16_f32 v123, v182, v183
    ds_read_b128 v[116:119], v5 offset:10240
    s_waitcnt lgkmcnt(5)
    v_mfma_f32_16x16x32_bf16 v[192:195], v[64:67], v[96:99], v[192:195]
    v_mfma_f32_16x16x32_bf16 v[196:199], v[68:71], v[96:99], v[196:199]
    v_permlane16_swap_b32 v120, v122
    v_permlane16_swap_b32 v121, v123
    v_mfma_f32_16x16x32_bf16 v[200:203], v[72:75], v[96:99], v[200:203]
    buffer_store_dwordx4 v[120:123], v16, s[44:47], 0 offen offset:3072 sc1
    v_cvt_pk_bf16_f32 v124, v184, v185
    v_mfma_f32_16x16x32_bf16 v[204:207], v[76:79], v[96:99], v[204:207]
    v_cvt_pk_bf16_f32 v125, v186, v187
    v_cvt_pk_bf16_f32 v126, v188, v189
    ds_read_b128 v[20:23], v10 offset:12288
    s_waitcnt lgkmcnt(5)
    v_mfma_f32_16x16x32_bf16 v[192:195], v[80:83], v[100:103], v[192:195]
    v_cvt_pk_bf16_f32 v127, v190, v191
    v_mfma_f32_16x16x32_bf16 v[196:199], v[84:87], v[100:103], v[196:199]
    v_permlane16_swap_b32 v124, v126
    v_mfma_f32_16x16x32_bf16 v[200:203], v[88:91], v[100:103], v[200:203]
    v_permlane16_swap_b32 v125, v127
    buffer_store_dwordx4 v[124:127], v16, s[44:47], s69 offen offset:3072 sc1
    v_mfma_f32_16x16x32_bf16 v[204:207], v[92:95], v[100:103], v[204:207]
    ds_read_b128 v[24:27], v11 offset:12288
    s_waitcnt lgkmcnt(5)
    v_mfma_f32_16x16x32_bf16 v[208:211], v[32:35], v[104:107], v[208:211]
    v_mfma_f32_16x16x32_bf16 v[212:215], v[36:39], v[104:107], v[212:215]
    v_mfma_f32_16x16x32_bf16 v[216:219], v[40:43], v[104:107], v[216:219]
    v_mfma_f32_16x16x32_bf16 v[220:223], v[44:47], v[104:107], v[220:223]
    ds_read_b128 v[96:99], v4 offset:12288
    s_waitcnt lgkmcnt(5)
    v_mfma_f32_16x16x32_bf16 v[208:211], v[48:51], v[108:111], v[208:211]
    v_mfma_f32_16x16x32_bf16 v[212:215], v[52:55], v[108:111], v[212:215]
    v_mfma_f32_16x16x32_bf16 v[216:219], v[56:59], v[108:111], v[216:219]
    v_cvt_pk_bf16_f32 v120, v192, v193
    v_cvt_pk_bf16_f32 v121, v194, v195
    v_mfma_f32_16x16x32_bf16 v[220:223], v[60:63], v[108:111], v[220:223]
    v_cvt_pk_bf16_f32 v122, v196, v197
    v_cvt_pk_bf16_f32 v123, v198, v199
    ds_read_b128 v[100:103], v5 offset:12288
    s_waitcnt lgkmcnt(5)
    v_mfma_f32_16x16x32_bf16 v[208:211], v[64:67], v[112:115], v[208:211]
    v_mfma_f32_16x16x32_bf16 v[212:215], v[68:71], v[112:115], v[212:215]
    v_permlane16_swap_b32 v120, v122
    v_permlane16_swap_b32 v121, v123
    v_mfma_f32_16x16x32_bf16 v[216:219], v[72:75], v[112:115], v[216:219]
    buffer_store_dwordx4 v[120:123], v16, s[44:47], s68 offen offset:0 sc1
    v_cvt_pk_bf16_f32 v124, v200, v201
    v_mfma_f32_16x16x32_bf16 v[220:223], v[76:79], v[112:115], v[220:223]
    v_cvt_pk_bf16_f32 v125, v202, v203
    v_cvt_pk_bf16_f32 v126, v204, v205
    ds_read_b128 v[104:107], v10 offset:14336
    s_waitcnt lgkmcnt(5)
    v_mfma_f32_16x16x32_bf16 v[208:211], v[80:83], v[116:119], v[208:211]
    v_cvt_pk_bf16_f32 v127, v206, v207
    v_mfma_f32_16x16x32_bf16 v[212:215], v[84:87], v[116:119], v[212:215]
    v_permlane16_swap_b32 v124, v126
    v_mfma_f32_16x16x32_bf16 v[216:219], v[88:91], v[116:119], v[216:219]
    v_permlane16_swap_b32 v125, v127
    buffer_store_dwordx4 v[124:127], v16, s[44:47], s70 offen offset:0 sc1
    v_mfma_f32_16x16x32_bf16 v[220:223], v[92:95], v[116:119], v[220:223]
    ds_read_b128 v[108:111], v11 offset:14336
    s_waitcnt lgkmcnt(5)
    v_mfma_f32_16x16x32_bf16 v[224:227], v[32:35], v[20:23], v[224:227]
    v_mfma_f32_16x16x32_bf16 v[228:231], v[36:39], v[20:23], v[228:231]
    v_mfma_f32_16x16x32_bf16 v[232:235], v[40:43], v[20:23], v[232:235]
    v_mfma_f32_16x16x32_bf16 v[236:239], v[44:47], v[20:23], v[236:239]
    ds_read_b128 v[112:115], v4 offset:14336
    s_waitcnt lgkmcnt(5)
    v_mfma_f32_16x16x32_bf16 v[224:227], v[48:51], v[24:27], v[224:227]
    v_mfma_f32_16x16x32_bf16 v[228:231], v[52:55], v[24:27], v[228:231]
    v_mfma_f32_16x16x32_bf16 v[232:235], v[56:59], v[24:27], v[232:235]
    v_cvt_pk_bf16_f32 v120, v208, v209
    v_cvt_pk_bf16_f32 v121, v210, v211
    v_mfma_f32_16x16x32_bf16 v[236:239], v[60:63], v[24:27], v[236:239]
    v_cvt_pk_bf16_f32 v122, v212, v213
    v_cvt_pk_bf16_f32 v123, v214, v215
    ds_read_b128 v[116:119], v5 offset:14336
    s_waitcnt lgkmcnt(5)
    v_mfma_f32_16x16x32_bf16 v[224:227], v[64:67], v[96:99], v[224:227]
    v_mfma_f32_16x16x32_bf16 v[228:231], v[68:71], v[96:99], v[228:231]
    v_permlane16_swap_b32 v120, v122
    v_permlane16_swap_b32 v121, v123
    v_mfma_f32_16x16x32_bf16 v[232:235], v[72:75], v[96:99], v[232:235]
    buffer_store_dwordx4 v[120:123], v16, s[44:47], s68 offen offset:1024 sc1
    v_cvt_pk_bf16_f32 v124, v216, v217
    v_mfma_f32_16x16x32_bf16 v[236:239], v[76:79], v[96:99], v[236:239]
    v_cvt_pk_bf16_f32 v125, v218, v219
    v_cvt_pk_bf16_f32 v126, v220, v221
    s_waitcnt lgkmcnt(4)
    v_mfma_f32_16x16x32_bf16 v[224:227], v[80:83], v[100:103], v[224:227]
    v_cvt_pk_bf16_f32 v127, v222, v223
    v_mfma_f32_16x16x32_bf16 v[228:231], v[84:87], v[100:103], v[228:231]
    v_permlane16_swap_b32 v124, v126
    v_mfma_f32_16x16x32_bf16 v[232:235], v[88:91], v[100:103], v[232:235]
    v_permlane16_swap_b32 v125, v127
    buffer_store_dwordx4 v[124:127], v16, s[44:47], s70 offen offset:1024 sc1
    v_mfma_f32_16x16x32_bf16 v[236:239], v[92:95], v[100:103], v[236:239]
    s_waitcnt lgkmcnt(3)
    v_mfma_f32_16x16x32_bf16 v[240:243], v[32:35], v[104:107], v[240:243]
    v_mfma_f32_16x16x32_bf16 v[244:247], v[36:39], v[104:107], v[244:247]
    v_mfma_f32_16x16x32_bf16 v[248:251], v[40:43], v[104:107], v[248:251]
    v_mfma_f32_16x16x32_bf16 v[252:255], v[44:47], v[104:107], v[252:255]
    s_waitcnt lgkmcnt(2)
    v_mfma_f32_16x16x32_bf16 v[240:243], v[48:51], v[108:111], v[240:243]
    v_mfma_f32_16x16x32_bf16 v[244:247], v[52:55], v[108:111], v[244:247]
    v_mfma_f32_16x16x32_bf16 v[248:251], v[56:59], v[108:111], v[248:251]
    v_cvt_pk_bf16_f32 v120, v224, v225
    v_cvt_pk_bf16_f32 v121, v226, v227
    v_mfma_f32_16x16x32_bf16 v[252:255], v[60:63], v[108:111], v[252:255]
    v_cvt_pk_bf16_f32 v122, v228, v229
    v_cvt_pk_bf16_f32 v123, v230, v231
    s_waitcnt lgkmcnt(1)
    v_mfma_f32_16x16x32_bf16 v[240:243], v[64:67], v[112:115], v[240:243]
    v_mfma_f32_16x16x32_bf16 v[244:247], v[68:71], v[112:115], v[244:247]
    v_permlane16_swap_b32 v120, v122
    v_permlane16_swap_b32 v121, v123
    v_mfma_f32_16x16x32_bf16 v[248:251], v[72:75], v[112:115], v[248:251]
    buffer_store_dwordx4 v[120:123], v16, s[44:47], s68 offen offset:2048 sc1
    v_cvt_pk_bf16_f32 v124, v232, v233
    v_mfma_f32_16x16x32_bf16 v[252:255], v[76:79], v[112:115], v[252:255]
    v_cvt_pk_bf16_f32 v125, v234, v235
    v_cvt_pk_bf16_f32 v126, v236, v237
    s_waitcnt lgkmcnt(0)
    v_mfma_f32_16x16x32_bf16 v[240:243], v[80:83], v[116:119], v[240:243]
    v_cvt_pk_bf16_f32 v127, v238, v239
    v_mfma_f32_16x16x32_bf16 v[244:247], v[84:87], v[116:119], v[244:247]
    v_permlane16_swap_b32 v124, v126
    v_mfma_f32_16x16x32_bf16 v[248:251], v[88:91], v[116:119], v[248:251]
    v_permlane16_swap_b32 v125, v127
    buffer_store_dwordx4 v[124:127], v16, s[44:47], s70 offen offset:2048 sc1
    v_mfma_f32_16x16x32_bf16 v[252:255], v[92:95], v[116:119], v[252:255]
    s_nop 7
    v_cvt_pk_bf16_f32 v120, v240, v241
    v_cvt_pk_bf16_f32 v121, v242, v243
    v_cvt_pk_bf16_f32 v122, v244, v245
    v_cvt_pk_bf16_f32 v123, v246, v247
    s_nop 0
    s_nop 0
    v_permlane16_swap_b32 v120, v122
    v_permlane16_swap_b32 v121, v123
    buffer_store_dwordx4 v[120:123], v16, s[44:47], s68 offen offset:3072 sc1
    v_cvt_pk_bf16_f32 v124, v248, v249
    v_cvt_pk_bf16_f32 v125, v250, v251
    v_cvt_pk_bf16_f32 v126, v252, v253
    v_cvt_pk_bf16_f32 v127, v254, v255
    s_nop 0
    s_nop 0
    v_permlane16_swap_b32 v124, v126
    v_permlane16_swap_b32 v125, v127
    buffer_store_dwordx4 v[124:127], v16, s[44:47], s70 offen offset:3072 sc1
    s_barrier
L_c_cons:
    s_waitcnt vmcnt(0)
    v_mov_b32 v7, 1
    s_mov_b64 exec, 1
    ds_add_u32 v2, v7
    s_mov_b64 exec, -1
L_c_cons2:
    s_and_b32 s52, s2, 7
    s_lshr_b32 s54, s2, 3
    s_lshr_b32 s4, s52, 1
    s_lshl_b32 s4, s4, 2
    s_and_b32 s55, s54, 3
    s_add_u32 s4, s4, s55
    s_and_b32 s5, s52, 1
    s_lshl_b32 s5, s5, 3
    s_lshr_b32 s54, s54, 2
    s_add_u32 s5, s5, s54
    s_lshl_b32 s52, s3, 11
    v_lshl_add_u32 v4, v0, 4, s52
    v_lshlrev_b32 v5, 4, v0
    v_add_u32 v5, 65536, v5
    v_mov_b32 v24, 0
    v_mov_b32 v25, 0
    v_mov_b32 v26, 0
    v_mov_b32 v27, 0
    v_mov_b32 v28, 0
    v_mov_b32 v29, 0
    v_mov_b32 v30, 0
    v_mov_b32 v31, 0
    v_mov_b32 v32, 0
    v_mov_b32 v33, 0
    v_mov_b32 v34, 0
    v_mov_b32 v35, 0
    v_mov_b32 v36, 0
    v_mov_b32 v37, 0
    v_mov_b32 v38, 0
    v_mov_b32 v39, 0
    v_mov_b32 v40, 0
    v_mov_b32 v41, 0
    v_mov_b32 v42, 0
    v_mov_b32 v43, 0
    v_mov_b32 v44, 0
    v_mov_b32 v45, 0
    v_mov_b32 v46, 0
    v_mov_b32 v47, 0
    v_mov_b32 v48, 0
    v_mov_b32 v49, 0
    v_mov_b32 v50, 0
    v_mov_b32 v51, 0
    v_mov_b32 v52, 0
    v_mov_b32 v53, 0
    v_mov_b32 v54, 0
    v_mov_b32 v55, 0
    v_mov_b32 v56, 0
    v_mov_b32 v57, 0
    v_mov_b32 v58, 0
    v_mov_b32 v59, 0
    v_mov_b32 v60, 0
    v_mov_b32 v61, 0
    v_mov_b32 v62, 0
    v_mov_b32 v63, 0
    v_mov_b32 v64, 0
    v_mov_b32 v65, 0
    v_mov_b32 v66, 0
    v_mov_b32 v67, 0
    v_mov_b32 v68, 0
    v_mov_b32 v69, 0
    v_mov_b32 v70, 0
    v_mov_b32 v71, 0
    v_mov_b32 v72, 0
    v_mov_b32 v73, 0
    v_mov_b32 v74, 0
    v_mov_b32 v75, 0
    v_mov_b32 v76, 0
    v_mov_b32 v77, 0
    v_mov_b32 v78, 0
    v_mov_b32 v79, 0
    s_mul_i32 s52, s3, 7680
    s_add_u32 s52, s52, 122880
    v_and_b32 v18, 15, v0
    v_mul_u32_u24 v18, 240, v18
    v_lshrrev_b32 v19, 4, v0
    v_lshl_add_u32 v20, v19, 4, v18
    v_add_u32 v8, s52, v20
    v_lshl_add_u32 v20, v19, 3, v18
    v_add_u32 v9, s52, v20
    s_mov_b32 s53, 0x12492493
    s_lshl_b32 s54, s4, 2
    s_add_u32 s54, s54, s3
    s_mul_i32 s54, s54, 110592
    s_mul_i32 s55, s5, 224
    s_add_u32 s54, s54, s55
    s_sub_u32 s55, 3456, s55
    v_mov_b32 v23, 0x7fffffff
    v_add_u32 v18, 0, v0
    v_mul_hi_u32 v19, v18, s53
    v_mul_u32_u24 v20, 14, v19
    v_sub_u32 v18, v18, v20
    v_lshlrev_b32 v18, 4, v18
    v_cmp_gt_u32 vcc, s55, v18
    v_mul_u32_u24 v20, 240, v19
    v_add3_u32 v152, v20, v18, s52
    v_mul_u32_u24 v20, 3456, v19
    v_add3_u32 v10, v20, v18, s54
    v_cndmask_b32 v10, v23, v10, vcc
    v_add_u32 v18, 64, v0
    v_mul_hi_u32 v19, v18, s53
    v_mul_u32_u24 v20, 14, v19
    v_sub_u32 v18, v18, v20
    v_lshlrev_b32 v18, 4, v18
    v_cmp_gt_u32 vcc, s55, v18
    v_mul_u32_u24 v20, 240, v19
    v_add3_u32 v153, v20, v18, s52
    v_mul_u32_u24 v20, 3456, v19
    v_add3_u32 v11, v20, v18, s54
    v_cndmask_b32 v11, v23, v11, vcc
    v_add_u32 v18, 128, v0
    v_mul_hi_u32 v19, v18, s53
    v_mul_u32_u24 v20, 14, v19
    v_sub_u32 v18, v18, v20
    v_lshlrev_b32 v18, 4, v18
    v_cmp_gt_u32 vcc, s55, v18
    v_mul_u32_u24 v20, 240, v19
    v_add3_u32 v154, v20, v18, s52
    v_mul_u32_u24 v20, 3456, v19
    v_add3_u32 v12, v20, v18, s54
    v_cndmask_b32 v12, v23, v12, vcc
    v_add_u32 v18, 192, v0
    v_mul_hi_u32 v19, v18, s53
    v_mul_u32_u24 v20, 14, v19
    v_sub_u32 v18, v18, v20
    v_lshlrev_b32 v18, 4, v18
    v_cmp_gt_u32 vcc, s55, v18
    v_mul_u32_u24 v20, 240, v19
    v_add3_u32 v155, v20, v18, s52
    v_mul_u32_u24 v20, 3456, v19
    v_add3_u32 v13, v20, v18, s54
    v_cndmask_b32 v13, v23, v13, vcc
    v_add_u32 v18, 256, v0
    v_mul_hi_u32 v19, v18, s53
    v_mul_u32_u24 v20, 14, v19
    v_sub_u32 v18, v18, v20
    v_lshlrev_b32 v18, 4, v18
    v_cmp_gt_u32 vcc, s55, v18
    v_mul_u32_u24 v20, 240, v19
    v_add3_u32 v156, v20, v18, s52
    v_mul_u32_u24 v20, 3456, v19
    v_add3_u32 v14, v20, v18, s54
    v_cndmask_b32 v14, v23, v14, vcc
    v_add_u32 v18, 320, v0
    v_mul_hi_u32 v19, v18, s53
    v_mul_u32_u24 v20, 14, v19
    v_sub_u32 v18, v18, v20
    v_lshlrev_b32 v18, 4, v18
    v_cmp_gt_u32 vcc, s55, v18
    v_mul_u32_u24 v20, 240, v19
    v_add3_u32 v157, v20, v18, s52
    v_mul_u32_u24 v20, 3456, v19
    v_add3_u32 v15, v20, v18, s54
    v_cndmask_b32 v15, v23, v15, vcc
    v_add_u32 v18, 384, v0
    v_mul_hi_u32 v19, v18, s53
    v_mul_u32_u24 v20, 14, v19
    v_sub_u32 v18, v18, v20
    v_lshlrev_b32 v18, 4, v18
    v_cmp_gt_u32 vcc, s55, v18
    v_mul_u32_u24 v20, 240, v19
    v_add3_u32 v158, v20, v18, s52
    v_mul_u32_u24 v20, 3456, v19
    v_add3_u32 v16, v20, v18, s54
    v_cndmask_b32 v16, v23, v16, vcc
    s_mov_b32 s28, s20
    s_and_b32 s29, s21, 0xffff
    s_mov_b32 s30, 7077888
    s_mov_b32 s31, 0x00020000
    s_mov_b32 s56, 0
    s_mov_b32 s57, 0
    v_add_u32 v6, s56, v4
    v_add_u32 v7, s57, v5
    s_add_u32 s56, s56, 16384
    s_cmp_eq_u32 s56, 65536
    s_cselect_b32 s56, 0, s56
    s_add_u32 s57, s57, 14336
    s_cmp_eq_u32 s57, 57344
    s_cselect_b32 s57, 0, s57
    s_mov_b32 s65, 0
    s_barrier
    ds_read_b128 v[108:111], v6 offset:0
    ds_read_b128 v[112:115], v6 offset:1024
    ds_read_b128 v[80:83], v7 offset:0
    ds_read_b128 v[84:87], v7 offset:1024
    ds_read_b128 v[88:91], v7 offset:2048
    ds_read_b128 v[92:95], v7 offset:3072
    ds_read_b128 v[96:99], v7 offset:4096
    ds_read_b128 v[100:103], v7 offset:5120
    ds_read_b128 v[104:107], v7 offset:6144
L_c_cloop:
    s_waitcnt lgkmcnt(4)
    v_mfma_f32_16x16x32_bf16 v[24:27], v[80:83], v[108:111], v[24:27]
    ds_read_b128 v[144:147], v6 offset:8192
    v_mfma_f32_16x16x32_bf16 v[52:55], v[80:83], v[112:115], v[52:55]
    ds_read_b128 v[148:151], v6 offset:9216
    v_mfma_f32_16x16x32_bf16 v[28:31], v[84:87], v[108:111], v[28:31]
    ds_read_b128 v[116:119], v7 offset:7168
    v_mfma_f32_16x16x32_bf16 v[56:59], v[84:87], v[112:115], v[56:59]
    v_mfma_f32_16x16x32_bf16 v[32:35], v[88:91], v[108:111], v[32:35]
    ds_read_b128 v[120:123], v7 offset:8192
    v_mfma_f32_16x16x32_bf16 v[60:63], v[88:91], v[112:115], v[60:63]
    ds_read_b128 v[124:127], v7 offset:9216
    s_waitcnt lgkmcnt(5)
    v_mfma_f32_16x16x32_bf16 v[36:39], v[92:95], v[108:111], v[36:39]
    v_mfma_f32_16x16x32_bf16 v[64:67], v[92:95], v[112:115], v[64:67]
    ds_read_b128 v[128:131], v7 offset:10240
    v_mfma_f32_16x16x32_bf16 v[40:43], v[96:99], v[108:111], v[40:43]
    ds_read_b128 v[132:135], v7 offset:11264
    v_mfma_f32_16x16x32_bf16 v[68:71], v[96:99], v[112:115], v[68:71]
    v_mfma_f32_16x16x32_bf16 v[44:47], v[100:103], v[108:111], v[44:47]
    ds_read_b128 v[136:139], v7 offset:12288
    v_mfma_f32_16x16x32_bf16 v[72:75], v[100:103], v[112:115], v[72:75]
    ds_read_b128 v[140:143], v7 offset:13312
    v_mfma_f32_16x16x32_bf16 v[48:51], v[104:107], v[108:111], v[48:51]
    v_add_u32 v6, s56, v4
    v_add_u32 v7, s57, v5
    v_mfma_f32_16x16x32_bf16 v[76:79], v[104:107], v[112:115], v[76:79]
    s_barrier
    s_waitcnt lgkmcnt(4)
    v_mfma_f32_16x16x32_bf16 v[24:27], v[116:119], v[144:147], v[24:27]
    ds_read_b128 v[108:111], v6 offset:0
    v_mfma_f32_16x16x32_bf16 v[52:55], v[116:119], v[148:151], v[52:55]
    ds_read_b128 v[112:115], v6 offset:1024
    v_mfma_f32_16x16x32_bf16 v[28:31], v[120:123], v[144:147], v[28:31]
    ds_read_b128 v[80:83], v7 offset:0
    v_mfma_f32_16x16x32_bf16 v[56:59], v[120:123], v[148:151], v[56:59]
    s_add_u32 s56, s56, 16384
    v_mfma_f32_16x16x32_bf16 v[32:35], v[124:127], v[144:147], v[32:35]
    ds_read_b128 v[84:87], v7 offset:1024
    v_mfma_f32_16x16x32_bf16 v[60:63], v[124:127], v[148:151], v[60:63]
    ds_read_b128 v[88:91], v7 offset:2048
    s_waitcnt lgkmcnt(5)
    v_mfma_f32_16x16x32_bf16 v[36:39], v[128:131], v[144:147], v[36:39]
    s_cmp_eq_u32 s56, 65536
    v_mfma_f32_16x16x32_bf16 v[64:67], v[128:131], v[148:151], v[64:67]
    ds_read_b128 v[92:95], v7 offset:3072
    v_mfma_f32_16x16x32_bf16 v[40:43], v[132:135], v[144:147], v[40:43]
    ds_read_b128 v[96:99], v7 offset:4096
    v_mfma_f32_16x16x32_bf16 v[68:71], v[132:135], v[148:151], v[68:71]
    s_cselect_b32 s56, 0, s56
    v_mfma_f32_16x16x32_bf16 v[44:47], v[136:139], v[144:147], v[44:47]
    ds_read_b128 v[100:103], v7 offset:5120
    v_mfma_f32_16x16x32_bf16 v[72:75], v[136:139], v[148:151], v[72:75]
    ds_read_b128 v[104:107], v7 offset:6144
    v_mfma_f32_16x16x32_bf16 v[48:51], v[140:143], v[144:147], v[48:51]
    s_add_u32 s57, s57, 14336
    s_cmp_eq_u32 s57, 57344
    v_mfma_f32_16x16x32_bf16 v[76:79], v[140:143], v[148:151], v[76:79]
    s_cselect_b32 s57, 0, s57
    s_add_u32 s65, s65, 1
    s_cmp_lt_u32 s65, 9
    s_cbranch_scc1 L_c_cloop
    s_waitcnt lgkmcnt(4)
    v_mfma_f32_16x16x32_bf16 v[24:27], v[80:83], v[108:111], v[24:27]
    ds_read_b128 v[144:147], v6 offset:8192
    v_mfma_f32_16x16x32_bf16 v[28:31], v[84:87], v[108:111], v[28:31]
    ds_read_b128 v[148:151], v6 offset:9216
    v_mfma_f32_16x16x32_bf16 v[32:35], v[88:91], v[108:111], v[32:35]
    ds_read_b128 v[116:119], v7 offset:7168
    s_waitcnt lgkmcnt(3)
    v_mfma_f32_16x16x32_bf16 v[36:39], v[92:95], v[108:111], v[36:39]
    ds_read_b128 v[120:123], v7 offset:8192
    v_mfma_f32_16x16x32_bf16 v[40:43], v[96:99], v[108:111], v[40:43]
    ds_read_b128 v[124:127], v7 offset:9216
    v_mfma_f32_16x16x32_bf16 v[44:47], v[100:103], v[108:111], v[44:47]
    ds_read_b128 v[128:131], v7 offset:10240
    v_mfma_f32_16x16x32_bf16 v[48:51], v[104:107], v[108:111], v[48:51]
    ds_read_b128 v[132:135], v7 offset:11264
    v_mfma_f32_16x16x32_bf16 v[52:55], v[80:83], v[112:115], v[52:55]
    ds_read_b128 v[136:139], v7 offset:12288
    v_mfma_f32_16x16x32_bf16 v[56:59], v[84:87], v[112:115], v[56:59]
    ds_read_b128 v[140:143], v7 offset:13312
    v_mfma_f32_16x16x32_bf16 v[60:63], v[88:91], v[112:115], v[60:63]
    v_mfma_f32_16x16x32_bf16 v[64:67], v[92:95], v[112:115], v[64:67]
    s_waitcnt lgkmcnt(6)
    v_mfma_f32_16x16x32_bf16 v[24:27], v[116:119], v[144:147], v[24:27]
    s_waitcnt lgkmcnt(5)
    v_mfma_f32_16x16x32_bf16 v[28:31], v[120:123], v[144:147], v[28:31]
    s_waitcnt lgkmcnt(4)
    v_mfma_f32_16x16x32_bf16 v[32:35], v[124:127], v[144:147], v[32:35]
    s_waitcnt lgkmcnt(3)
    v_mfma_f32_16x16x32_bf16 v[36:39], v[128:131], v[144:147], v[36:39]
    s_waitcnt lgkmcnt(2)
    v_mfma_f32_16x16x32_bf16 v[40:43], v[132:135], v[144:147], v[40:43]
    s_waitcnt lgkmcnt(1)
    v_mfma_f32_16x16x32_bf16 v[44:47], v[136:139], v[144:147], v[44:47]
    s_waitcnt lgkmcnt(0)
    v_mfma_f32_16x16x32_bf16 v[48:51], v[140:143], v[144:147], v[48:51]
    v_mfma_f32_16x16x32_bf16 v[68:71], v[96:99], v[112:115], v[68:71]
    v_mfma_f32_16x16x32_bf16 v[72:75], v[100:103], v[112:115], v[72:75]
    v_cvt_pk_bf16_f32 v160, v24, v25
    v_cvt_pk_bf16_f32 v161, v26, v27
    v_cvt_pk_bf16_f32 v162, v28, v29
    v_mfma_f32_16x16x32_bf16 v[76:79], v[104:107], v[112:115], v[76:79]
    v_cvt_pk_bf16_f32 v163, v30, v31
    ds_write_b128 v8, v[160:163] offset:0
    v_cvt_pk_bf16_f32 v168, v32, v33
    v_mfma_f32_16x16x32_bf16 v[52:55], v[116:119], v[148:151], v[52:55]
    v_cvt_pk_bf16_f32 v169, v34, v35
    v_cvt_pk_bf16_f32 v170, v36, v37
    v_cvt_pk_bf16_f32 v171, v38, v39
    v_mfma_f32_16x16x32_bf16 v[56:59], v[120:123], v[148:151], v[56:59]
    ds_write_b128 v8, v[168:171] offset:64
    v_cvt_pk_bf16_f32 v176, v40, v41
    v_cvt_pk_bf16_f32 v177, v42, v43
    v_mfma_f32_16x16x32_bf16 v[60:63], v[124:127], v[148:151], v[60:63]
    v_cvt_pk_bf16_f32 v178, v44, v45
    v_cvt_pk_bf16_f32 v179, v46, v47
    ds_write_b128 v8, v[176:179] offset:128
    v_mfma_f32_16x16x32_bf16 v[64:67], v[128:131], v[148:151], v[64:67]
    v_cvt_pk_bf16_f32 v184, v48, v49
    v_cvt_pk_bf16_f32 v185, v50, v51
    ds_write_b64 v9, v[184:185] offset:192
    v_mfma_f32_16x16x32_bf16 v[68:71], v[132:135], v[148:151], v[68:71]
    ds_read_b128 v[192:195], v152
    ds_read_b128 v[196:199], v153
    ds_read_b128 v[200:203], v154
    v_mfma_f32_16x16x32_bf16 v[72:75], v[136:139], v[148:151], v[72:75]
    v_mfma_f32_16x16x32_bf16 v[76:79], v[140:143], v[148:151], v[76:79]
    s_waitcnt lgkmcnt(2)
    buffer_store_dwordx4 v[192:195], v10, s[28:31], 0 offen
    s_waitcnt lgkmcnt(1)
    buffer_store_dwordx4 v[196:199], v11, s[28:31], 0 offen
    s_waitcnt lgkmcnt(0)
    buffer_store_dwordx4 v[200:203], v12, s[28:31], 0 offen
    v_cvt_pk_bf16_f32 v164, v52, v53
    v_cvt_pk_bf16_f32 v165, v54, v55
    v_cvt_pk_bf16_f32 v166, v56, v57
    v_cvt_pk_bf16_f32 v167, v58, v59
    ds_write_b128 v8, v[164:167] offset:3840
    v_cvt_pk_bf16_f32 v172, v60, v61
    v_cvt_pk_bf16_f32 v173, v62, v63
    v_cvt_pk_bf16_f32 v174, v64, v65
    v_cvt_pk_bf16_f32 v175, v66, v67
    ds_write_b128 v8, v[172:175] offset:3904
    v_cvt_pk_bf16_f32 v180, v68, v69
    v_cvt_pk_bf16_f32 v181, v70, v71
    v_cvt_pk_bf16_f32 v182, v72, v73
    v_cvt_pk_bf16_f32 v183, v74, v75
    ds_write_b128 v8, v[180:183] offset:3968
    v_cvt_pk_bf16_f32 v188, v76, v77
    v_cvt_pk_bf16_f32 v189, v78, v79
    ds_write_b64 v9, v[188:189] offset:4032
    ds_read_b128 v[204:207], v155
    ds_read_b128 v[208:211], v156
    ds_read_b128 v[212:215], v157
    ds_read_b128 v[216:219], v158
    s_waitcnt lgkmcnt(3)
    buffer_store_dwordx4 v[204:207], v13, s[28:31], 0 offen
    s_waitcnt lgkmcnt(2)
    buffer_store_dwordx4 v[208:211], v14, s[28:31], 0 offen
    s_waitcnt lgkmcnt(1)
    buffer_store_dwordx4 v[212:215], v15, s[28:31], 0 offen
    s_waitcnt lgkmcnt(0)
    buffer_store_dwordx4 v[216:219], v16, s[28:31], 0 offen
    s_endpgm
L_c_ld:
    s_and_b32 s52, s2, 7
    s_lshr_b32 s54, s2, 3
    s_lshr_b32 s4, s52, 1
    s_lshl_b32 s4, s4, 2
    s_and_b32 s55, s54, 3
    s_add_u32 s4, s4, s55
    s_and_b32 s5, s52, 1
    s_lshl_b32 s5, s5, 3
    s_lshr_b32 s54, s54, 2
    s_add_u32 s5, s5, s54
    s_and_b32 s62, s3, 1
    s_lshl_b32 s52, s4, 4
    s_add_u32 s52, s52, s5
    s_lshl_b32 s52, s52, 8
    s_add_u32 s52, s52, 65536
    v_lshl_add_u32 v8, v0, 2, s52
    s_mov_b32 s63, 0
    s_add_u32 s52, s4, s5
    s_and_b32 s52, s52, 3
    s_mov_b32 s68, 0x75436210
    s_mov_b32 s69, 0x98
    s_cmp_eq_u32 s52, 1
    s_cselect_b32 s68, 0x65472310, s68
    s_cselect_b32 s69, 0x98, s69
    s_cmp_eq_u32 s52, 2
    s_cselect_b32 s68, 0x65832410, s68
    s_cselect_b32 s69, 0x97, s69
    s_cmp_eq_u32 s52, 3
    s_cselect_b32 s68, 0x69432510, s68
    s_cselect_b32 s69, 0x87, s69
    s_cmp_ge_u32 s3, 6
    s_cbranch_scc1 L_c_xl
    s_mul_i32 s52, s5, 7
    s_add_u32 s54, s52, 6
    s_lshr_b32 s52, s52, 2
    s_lshr_b32 s54, s54, 2
    s_min_u32 s54, s54, 26
    s_sub_u32 s52, s54, s52
    s_mov_b32 s66, 1
    s_cmp_ge_u32 s52, 1
    s_cselect_b32 s66, 0x101, s66
    s_cmp_ge_u32 s52, 2
    s_cselect_b32 s66, 0x10101, s66
    s_mul_i32 s52, s5, 143360
    s_add_u32 s52, s52, 2359296
    s_mul_i32 s55, s62, 7168
    s_add_u32 s52, s52, s55
    v_lshl_add_u32 v4, v0, 4, s52
    v_add_u32 v5, 4096, v4
    v_mov_b32 v6, v4
    s_cmp_lg_u32 s5, 15
    s_cbranch_scc1 L_c_nt15
    v_mov_b32 v5, 0x7fffffff
    v_and_b32 v7, 8, v0
    v_cmp_eq_u32 vcc, 0, v7
    s_nop 1
    v_cndmask_b32 v6, v5, v4, vcc
L_c_nt15:
    s_add_u32 s55, s55, 65536
    s_barrier
    s_cmp_lg_u32 s3, 5
    s_cbranch_scc1 L_c_nopush
    s_cmp_eq_u32 s74, 0
    s_cbranch_scc1 L_c_nopush
    s_waitcnt vmcnt(0)
    v_add_u32 v19, 1540483477, v19
    s_mov_b32 exec_lo, s74
    s_mov_b32 exec_hi, 0
    s_mov_b32 s80, 0
L_c_own:
    ds_read_b32 v30, v2
    s_add_u32 s80, s80, 1
    s_cmp_ge_u32 s80, 524288
    s_cbranch_scc1 L_c_own_done
    s_waitcnt lgkmcnt(0)
    v_readfirstlane_b32 s52, v30
    s_cmp_ge_u32 s52, s53
    s_cbranch_scc0 L_c_own
L_c_own_done:
    buffer_atomic_swap v19, v17, s[44:47], s75 offen sc1
    s_mov_b64 exec, -1
    s_branch L_c_pushed
L_c_nopush:
    s_mov_b32 s80, 0
L_c_own4:
    s_sleep 1
    ds_read_b32 v30, v2
    s_add_u32 s80, s80, 1
    s_cmp_ge_u32 s80, 524288
    s_cbranch_scc1 L_c_own4_done
    s_waitcnt lgkmcnt(0)
    v_readfirstlane_b32 s52, v30
    s_cmp_ge_u32 s52, s53
    s_cbranch_scc0 L_c_own4
L_c_own4_done:
L_c_pushed:
    s_mul_i32 s76, s66, 3
    s_and_b32 s52, s63, s76
    s_cmp_eq_u32 s52, s76
    s_cbranch_scc1 L_ok1
    s_call_b64 s[78:79], L_poll
L_ok1:
    s_bfe_u32 s58, s68, 0x40000
    s_mul_i32 s58, s58, 14336
    s_add_u32 m0, s55, 0
    s_nop 0
    buffer_load_dwordx4 v4, s[44:47], s58 offen offset:0 sc1 lds
    buffer_load_dwordx4 v4, s[44:47], s58 offen offset:1024 sc1 lds
    buffer_load_dwordx4 v6, s[44:47], s58 offen offset:2048 sc1 lds
    buffer_load_dwordx4 v6, s[44:47], s58 offen offset:3072 sc1 lds
    s_add_u32 m0, m0, 4096
    s_nop 0
    buffer_load_dwordx4 v5, s[44:47], s58 offen offset:0 sc1 lds
    buffer_load_dwordx4 v5, s[44:47], s58 offen offset:1024 sc1 lds
    buffer_load_dwordx4 v5, s[44:47], s58 offen offset:2048 sc1 lds
    s_mul_i32 s76, s66, 3
    s_and_b32 s52, s63, s76
    s_cmp_eq_u32 s52, s76
    s_cbranch_scc1 L_ok2
    s_call_b64 s[78:79], L_poll
L_ok2:
    s_bfe_u32 s58, s68, 0x40004
    s_mul_i32 s58, s58, 14336
    s_add_u32 m0, s55, 14336
    s_nop 0
    buffer_load_dwordx4 v4, s[44:47], s58 offen offset:0 sc1 lds
    buffer_load_dwordx4 v4, s[44:47], s58 offen offset:1024 sc1 lds
    buffer_load_dwordx4 v6, s[44:47], s58 offen offset:2048 sc1 lds
    buffer_load_dwordx4 v6, s[44:47], s58 offen offset:3072 sc1 lds
    s_add_u32 m0, m0, 4096
    s_nop 0
    buffer_load_dwordx4 v5, s[44:47], s58 offen offset:0 sc1 lds
    buffer_load_dwordx4 v5, s[44:47], s58 offen offset:1024 sc1 lds
    buffer_load_dwordx4 v5, s[44:47], s58 offen offset:2048 sc1 lds
    s_mul_i32 s76, s66, 255
    s_and_b32 s52, s63, s76
    s_cmp_eq_u32 s52, s76
    s_cbranch_scc1 L_ok3
    s_call_b64 s[78:79], L_poll
L_ok3:
    s_bfe_u32 s58, s68, 0x40008
    s_mul_i32 s58, s58, 14336
    s_add_u32 m0, s55, 28672
    s_nop 0
    buffer_load_dwordx4 v4, s[44:47], s58 offen offset:0 sc1 lds
    buffer_load_dwordx4 v4, s[44:47], s58 offen offset:1024 sc1 lds
    buffer_load_dwordx4 v6, s[44:47], s58 offen offset:2048 sc1 lds
    buffer_load_dwordx4 v6, s[44:47], s58 offen offset:3072 sc1 lds
    s_add_u32 m0, m0, 4096
    s_nop 0
    buffer_load_dwordx4 v5, s[44:47], s58 offen offset:0 sc1 lds
    buffer_load_dwordx4 v5, s[44:47], s58 offen offset:1024 sc1 lds
    buffer_load_dwordx4 v5, s[44:47], s58 offen offset:2048 sc1 lds
    s_bfe_u32 s58, s68, 0x4000c
    s_mul_i32 s58, s58, 14336
    s_add_u32 m0, s55, 43008
    s_waitcnt vmcnt(14)
    s_barrier
    buffer_load_dwordx4 v4, s[44:47], s58 offen offset:0 sc1 lds
    buffer_load_dwordx4 v4, s[44:47], s58 offen offset:1024 sc1 lds
    buffer_load_dwordx4 v6, s[44:47], s58 offen offset:2048 sc1 lds
    buffer_load_dwordx4 v6, s[44:47], s58 offen offset:3072 sc1 lds
    s_add_u32 m0, m0, 4096
    s_nop 0
    buffer_load_dwordx4 v5, s[44:47], s58 offen offset:0 sc1 lds
    buffer_load_dwordx4 v5, s[44:47], s58 offen offset:1024 sc1 lds
    buffer_load_dwordx4 v5, s[44:47], s58 offen offset:2048 sc1 lds
    s_waitcnt vmcnt(14)
    s_barrier
    s_bfe_u32 s58, s68, 0x40010
    s_mul_i32 s58, s58, 14336
    s_add_u32 m0, s55, 0
    s_waitcnt vmcnt(7)
    s_barrier
    buffer_load_dwordx4 v4, s[44:47], s58 offen offset:0 sc1 lds
    buffer_load_dwordx4 v4, s[44:47], s58 offen offset:1024 sc1 lds
    buffer_load_dwordx4 v6, s[44:47], s58 offen offset:2048 sc1 lds
    buffer_load_dwordx4 v6, s[44:47], s58 offen offset:3072 sc1 lds
    s_add_u32 m0, m0, 4096
    s_nop 0
    buffer_load_dwordx4 v5, s[44:47], s58 offen offset:0 sc1 lds
    buffer_load_dwordx4 v5, s[44:47], s58 offen offset:1024 sc1 lds
    buffer_load_dwordx4 v5, s[44:47], s58 offen offset:2048 sc1 lds
    s_bfe_u32 s58, s68, 0x40014
    s_mul_i32 s58, s58, 14336
    s_add_u32 m0, s55, 14336
    s_waitcnt vmcnt(7)
    s_barrier
    buffer_load_dwordx4 v4, s[44:47], s58 offen offset:0 sc1 lds
    buffer_load_dwordx4 v4, s[44:47], s58 offen offset:1024 sc1 lds
    buffer_load_dwordx4 v6, s[44:47], s58 offen offset:2048 sc1 lds
    buffer_load_dwordx4 v6, s[44:47], s58 offen offset:3072 sc1 lds
    s_add_u32 m0, m0, 4096
    s_nop 0
    buffer_load_dwordx4 v5, s[44:47], s58 offen offset:0 sc1 lds
    buffer_load_dwordx4 v5, s[44:47], s58 offen offset:1024 sc1 lds
    buffer_load_dwordx4 v5, s[44:47], s58 offen offset:2048 sc1 lds
    s_bfe_u32 s58, s68, 0x40018
    s_mul_i32 s58, s58, 14336
    s_add_u32 m0, s55, 28672
    s_waitcnt vmcnt(7)
    s_barrier
    buffer_load_dwordx4 v4, s[44:47], s58 offen offset:0 sc1 lds
    buffer_load_dwordx4 v4, s[44:47], s58 offen offset:1024 sc1 lds
    buffer_load_dwordx4 v6, s[44:47], s58 offen offset:2048 sc1 lds
    buffer_load_dwordx4 v6, s[44:47], s58 offen offset:3072 sc1 lds
    s_add_u32 m0, m0, 4096
    s_nop 0
    buffer_load_dwordx4 v5, s[44:47], s58 offen offset:0 sc1 lds
    buffer_load_dwordx4 v5, s[44:47], s58 offen offset:1024 sc1 lds
    buffer_load_dwordx4 v5, s[44:47], s58 offen offset:2048 sc1 lds
    s_bfe_u32 s58, s68, 0x4001c
    s_mul_i32 s58, s58, 14336
    s_add_u32 m0, s55, 43008
    s_waitcnt vmcnt(7)
    s_barrier
    buffer_load_dwordx4 v4, s[44:47], s58 offen offset:0 sc1 lds
    buffer_load_dwordx4 v4, s[44:47], s58 offen offset:1024 sc1 lds
    buffer_load_dwordx4 v6, s[44:47], s58 offen offset:2048 sc1 lds
    buffer_load_dwordx4 v6, s[44:47], s58 offen offset:3072 sc1 lds
    s_add_u32 m0, m0, 4096
    s_nop 0
    buffer_load_dwordx4 v5, s[44:47], s58 offen offset:0 sc1 lds
    buffer_load_dwordx4 v5, s[44:47], s58 offen offset:1024 sc1 lds
    buffer_load_dwordx4 v5, s[44:47], s58 offen offset:2048 sc1 lds
    s_bfe_u32 s58, s69, 0x40000
    s_mul_i32 s58, s58, 14336
    s_add_u32 m0, s55, 0
    s_waitcnt vmcnt(7)
    s_barrier
    buffer_load_dwordx4 v4, s[44:47], s58 offen offset:0 sc1 lds
    buffer_load_dwordx4 v4, s[44:47], s58 offen offset:1024 sc1 lds
    buffer_load_dwordx4 v6, s[44:47], s58 offen offset:2048 sc1 lds
    buffer_load_dwordx4 v6, s[44:47], s58 offen offset:3072 sc1 lds
    s_add_u32 m0, m0, 4096
    s_nop 0
    buffer_load_dwordx4 v5, s[44:47], s58 offen offset:0 sc1 lds
    buffer_load_dwordx4 v5, s[44:47], s58 offen offset:1024 sc1 lds
    buffer_load_dwordx4 v5, s[44:47], s58 offen offset:2048 sc1 lds
    s_bfe_u32 s58, s69, 0x40004
    s_mul_i32 s58, s58, 14336
    s_add_u32 m0, s55, 14336
    s_waitcnt vmcnt(7)
    s_barrier
    buffer_load_dwordx4 v4, s[44:47], s58 offen offset:0 sc1 lds
    buffer_load_dwordx4 v4, s[44:47], s58 offen offset:1024 sc1 lds
    buffer_load_dwordx4 v6, s[44:47], s58 offen offset:2048 sc1 lds
    buffer_load_dwordx4 v6, s[44:47], s58 offen offset:3072 sc1 lds
    s_add_u32 m0, m0, 4096
    s_nop 0
    buffer_load_dwordx4 v5, s[44:47], s58 offen offset:0 sc1 lds
    buffer_load_dwordx4 v5, s[44:47], s58 offen offset:1024 sc1 lds
    buffer_load_dwordx4 v5, s[44:47], s58 offen offset:2048 sc1 lds
    s_waitcnt vmcnt(7)
    s_barrier
    s_waitcnt vmcnt(0)
    s_barrier
    s_cmp_lg_u32 s3, 4
    s_cbranch_scc1 L_c_nobump
    v_mov_b32 v30, 1
    s_mov_b64 exec, 1
    buffer_atomic_add v30, v8, s[44:47], 0 offen offset:124 sc1
    s_mov_b64 exec, -1
L_c_nobump:
    s_endpgm
L_c_xl:
    s_mul_i32 s52, s4, 163840
    s_add_u32 s52, s52, 4718592
    s_lshl_b32 s55, s62, 13
    s_add_u32 s52, s52, s55
    v_lshl_add_u32 v4, v0, 4, s52
    v_add_u32 v5, 4096, v4
    s_barrier
    s_mov_b32 s80, 0
L_c_xh:
    s_sleep 1
    ds_read_b32 v30, v2
    s_add_u32 s80, s80, 1
    s_cmp_ge_u32 s80, 524288
    s_cbranch_scc1 L_c_xh_done
    s_waitcnt lgkmcnt(0)
    v_readfirstlane_b32 s52, v30
    s_cmp_ge_u32 s52, s53
    s_cbranch_scc0 L_c_xh
L_c_xh_done:
    s_mov_b32 s76, 16777216
    s_and_b32 s52, s63, s76
    s_cmp_eq_u32 s52, s76
    s_cbranch_scc1 L_ok4
    s_call_b64 s[78:79], L_poll
L_ok4:
    s_bfe_u32 s58, s68, 0x40000
    s_mul_i32 s58, s58, 16384
    s_add_u32 m0, s55, 0
    s_nop 0
    buffer_load_dwordx4 v4, s[44:47], s58 offen offset:0 sc1 lds
    buffer_load_dwordx4 v4, s[44:47], s58 offen offset:1024 sc1 lds
    buffer_load_dwordx4 v4, s[44:47], s58 offen offset:2048 sc1 lds
    buffer_load_dwordx4 v4, s[44:47], s58 offen offset:3072 sc1 lds
    s_add_u32 m0, m0, 4096
    s_nop 0
    buffer_load_dwordx4 v5, s[44:47], s58 offen offset:0 sc1 lds
    buffer_load_dwordx4 v5, s[44:47], s58 offen offset:1024 sc1 lds
    buffer_load_dwordx4 v5, s[44:47], s58 offen offset:2048 sc1 lds
    buffer_load_dwordx4 v5, s[44:47], s58 offen offset:3072 sc1 lds
    s_bfe_u32 s58, s68, 0x40004
    s_mul_i32 s58, s58, 16384
    s_add_u32 m0, s55, 16384
    s_nop 0
    buffer_load_dwordx4 v4, s[44:47], s58 offen offset:0 sc1 lds
    buffer_load_dwordx4 v4, s[44:47], s58 offen offset:1024 sc1 lds
    buffer_load_dwordx4 v4, s[44:47], s58 offen offset:2048 sc1 lds
    buffer_load_dwordx4 v4, s[44:47], s58 offen offset:3072 sc1 lds
    s_add_u32 m0, m0, 4096
    s_nop 0
    buffer_load_dwordx4 v5, s[44:47], s58 offen offset:0 sc1 lds
    buffer_load_dwordx4 v5, s[44:47], s58 offen offset:1024 sc1 lds
    buffer_load_dwordx4 v5, s[44:47], s58 offen offset:2048 sc1 lds
    buffer_load_dwordx4 v5, s[44:47], s58 offen offset:3072 sc1 lds
    s_mov_b32 s76, 520093696
    s_and_b32 s52, s63, s76
    s_cmp_eq_u32 s52, s76
    s_cbranch_scc1 L_ok5
    s_call_b64 s[78:79], L_poll
L_ok5:
    s_bfe_u32 s58, s68, 0x40008
    s_mul_i32 s58, s58, 16384
    s_add_u32 m0, s55, 32768
    s_waitcnt vmcnt(8)
    s_barrier
    buffer_load_dwordx4 v4, s[44:47], s58 offen offset:0 sc1 lds
    buffer_load_dwordx4 v4, s[44:47], s58 offen offset:1024 sc1 lds
    buffer_load_dwordx4 v4, s[44:47], s58 offen offset:2048 sc1 lds
    buffer_load_dwordx4 v4, s[44:47], s58 offen offset:3072 sc1 lds
    s_add_u32 m0, m0, 4096
    s_nop 0
    buffer_load_dwordx4 v5, s[44:47], s58 offen offset:0 sc1 lds
    buffer_load_dwordx4 v5, s[44:47], s58 offen offset:1024 sc1 lds
    buffer_load_dwordx4 v5, s[44:47], s58 offen offset:2048 sc1 lds
    buffer_load_dwordx4 v5, s[44:47], s58 offen offset:3072 sc1 lds
    s_bfe_u32 s58, s68, 0x4000c
    s_mul_i32 s58, s58, 16384
    s_add_u32 m0, s55, 49152
    s_nop 0
    buffer_load_dwordx4 v4, s[44:47], s58 offen offset:0 sc1 lds
    buffer_load_dwordx4 v4, s[44:47], s58 offen offset:1024 sc1 lds
    buffer_load_dwordx4 v4, s[44:47], s58 offen offset:2048 sc1 lds
    buffer_load_dwordx4 v4, s[44:47], s58 offen offset:3072 sc1 lds
    s_add_u32 m0, m0, 4096
    s_nop 0
    buffer_load_dwordx4 v5, s[44:47], s58 offen offset:0 sc1 lds
    buffer_load_dwordx4 v5, s[44:47], s58 offen offset:1024 sc1 lds
    buffer_load_dwordx4 v5, s[44:47], s58 offen offset:2048 sc1 lds
    buffer_load_dwordx4 v5, s[44:47], s58 offen offset:3072 sc1 lds
    s_waitcnt vmcnt(16)
    s_barrier
    s_bfe_u32 s58, s68, 0x40010
    s_mul_i32 s58, s58, 16384
    s_add_u32 m0, s55, 0
    s_waitcnt vmcnt(8)
    s_barrier
    buffer_load_dwordx4 v4, s[44:47], s58 offen offset:0 sc1 lds
    buffer_load_dwordx4 v4, s[44:47], s58 offen offset:1024 sc1 lds
    buffer_load_dwordx4 v4, s[44:47], s58 offen offset:2048 sc1 lds
    buffer_load_dwordx4 v4, s[44:47], s58 offen offset:3072 sc1 lds
    s_add_u32 m0, m0, 4096
    s_nop 0
    buffer_load_dwordx4 v5, s[44:47], s58 offen offset:0 sc1 lds
    buffer_load_dwordx4 v5, s[44:47], s58 offen offset:1024 sc1 lds
    buffer_load_dwordx4 v5, s[44:47], s58 offen offset:2048 sc1 lds
    buffer_load_dwordx4 v5, s[44:47], s58 offen offset:3072 sc1 lds
    s_bfe_u32 s58, s68, 0x40014
    s_mul_i32 s58, s58, 16384
    s_add_u32 m0, s55, 16384
    s_waitcnt vmcnt(8)
    s_barrier
    buffer_load_dwordx4 v4, s[44:47], s58 offen offset:0 sc1 lds
    buffer_load_dwordx4 v4, s[44:47], s58 offen offset:1024 sc1 lds
    buffer_load_dwordx4 v4, s[44:47], s58 offen offset:2048 sc1 lds
    buffer_load_dwordx4 v4, s[44:47], s58 offen offset:3072 sc1 lds
    s_add_u32 m0, m0, 4096
    s_nop 0
    buffer_load_dwordx4 v5, s[44:47], s58 offen offset:0 sc1 lds
    buffer_load_dwordx4 v5, s[44:47], s58 offen offset:1024 sc1 lds
    buffer_load_dwordx4 v5, s[44:47], s58 offen offset:2048 sc1 lds
    buffer_load_dwordx4 v5, s[44:47], s58 offen offset:3072 sc1 lds
    s_bfe_u32 s58, s68, 0x40018
    s_mul_i32 s58, s58, 16384
    s_add_u32 m0, s55, 32768
    s_waitcnt vmcnt(8)
    s_barrier
    buffer_load_dwordx4 v4, s[44:47], s58 offen offset:0 sc1 lds
    buffer_load_dwordx4 v4, s[44:47], s58 offen offset:1024 sc1 lds
    buffer_load_dwordx4 v4, s[44:47], s58 offen offset:2048 sc1 lds
    buffer_load_dwordx4 v4, s[44:47], s58 offen offset:3072 sc1 lds
    s_add_u32 m0, m0, 4096
    s_nop 0
    buffer_load_dwordx4 v5, s[44:47], s58 offen offset:0 sc1 lds
    buffer_load_dwordx4 v5, s[44:47], s58 offen offset:1024 sc1 lds
    buffer_load_dwordx4 v5, s[44:47], s58 offen offset:2048 sc1 lds
    buffer_load_dwordx4 v5, s[44:47], s58 offen offset:3072 sc1 lds
    s_bfe_u32 s58, s68, 0x4001c
    s_mul_i32 s58, s58, 16384
    s_add_u32 m0, s55, 49152
    s_waitcnt vmcnt(8)
    s_barrier
    buffer_load_dwordx4 v4, s[44:47], s58 offen offset:0 sc1 lds
    buffer_load_dwordx4 v4, s[44:47], s58 offen offset:1024 sc1 lds
    buffer_load_dwordx4 v4, s[44:47], s58 offen offset:2048 sc1 lds
    buffer_load_dwordx4 v4, s[44:47], s58 offen offset:3072 sc1 lds
    s_add_u32 m0, m0, 4096
    s_nop 0
    buffer_load_dwordx4 v5, s[44:47], s58 offen offset:0 sc1 lds
    buffer_load_dwordx4 v5, s[44:47], s58 offen offset:1024 sc1 lds
    buffer_load_dwordx4 v5, s[44:47], s58 offen offset:2048 sc1 lds
    buffer_load_dwordx4 v5, s[44:47], s58 offen offset:3072 sc1 lds
    s_bfe_u32 s58, s69, 0x40000
    s_mul_i32 s58, s58, 16384
    s_add_u32 m0, s55, 0
    s_waitcnt vmcnt(8)
    s_barrier
    buffer_load_dwordx4 v4, s[44:47], s58 offen offset:0 sc1 lds
    buffer_load_dwordx4 v4, s[44:47], s58 offen offset:1024 sc1 lds
    buffer_load_dwordx4 v4, s[44:47], s58 offen offset:2048 sc1 lds
    buffer_load_dwordx4 v4, s[44:47], s58 offen offset:3072 sc1 lds
    s_add_u32 m0, m0, 4096
    s_nop 0
    buffer_load_dwordx4 v5, s[44:47], s58 offen offset:0 sc1 lds
    buffer_load_dwordx4 v5, s[44:47], s58 offen offset:1024 sc1 lds
    buffer_load_dwordx4 v5, s[44:47], s58 offen offset:2048 sc1 lds
    buffer_load_dwordx4 v5, s[44:47], s58 offen offset:3072 sc1 lds
    s_bfe_u32 s58, s69, 0x40004
    s_mul_i32 s58, s58, 16384
    s_add_u32 m0, s55, 16384
    s_waitcnt vmcnt(8)
    s_barrier
    buffer_load_dwordx4 v4, s[44:47], s58 offen offset:0 sc1 lds
    buffer_load_dwordx4 v4, s[44:47], s58 offen offset:1024 sc1 lds
    buffer_load_dwordx4 v4, s[44:47], s58 offen offset:2048 sc1 lds
    buffer_load_dwordx4 v4, s[44:47], s58 offen offset:3072 sc1 lds
    s_add_u32 m0, m0, 4096
    s_nop 0
    buffer_load_dwordx4 v5, s[44:47], s58 offen offset:0 sc1 lds
    buffer_load_dwordx4 v5, s[44:47], s58 offen offset:1024 sc1 lds
    buffer_load_dwordx4 v5, s[44:47], s58 offen offset:2048 sc1 lds
    buffer_load_dwordx4 v5, s[44:47], s58 offen offset:3072 sc1 lds
    s_waitcnt vmcnt(8)
    s_barrier
    s_waitcnt vmcnt(0)
    s_barrier
    s_endpgm
L_end:
    s_endpgm
.section .rodata,"a"
.p2align 6
.amdhsa_kernel standalone__weight_only_int_quip__prompt_kernel
  .amdhsa_next_free_vgpr 256
  .amdhsa_next_free_sgpr 102
  .amdhsa_accum_offset 256
  .amdhsa_group_segment_fixed_size 0
  .amdhsa_kernarg_size 72
  .amdhsa_user_sgpr_count 2
  .amdhsa_user_sgpr_kernarg_segment_ptr 1
  .amdhsa_system_sgpr_workgroup_id_x 1
.end_amdhsa_kernel
```
